```python
import torch

def _softmax(x, axis=-1):
    return torch.softmax(x, dim=axis)
def _gelu(x):
    return torch.nn.functional.gelu(x, approximate="tanh")
def _silu(x):
    return torch.nn.functional.silu(x)
def _sigmoid(x):
    return torch.sigmoid(x)
def _layernorm(x, axis=-1, eps=1e-5):
    m = x.mean(dim=axis, keepdim=True)
    v = x.var(dim=axis, keepdim=True, unbiased=False)
    return (x - m) / torch.sqrt(v + eps)
def _scatter_add(tgt, idx, src, axis=0):
    return tgt.clone().index_add_(axis, idx, src)
def _segment_sum(src, seg, n):
    out = torch.zeros((n,) + src.shape[1:], dtype=src.dtype)
    return out.index_add_(0, seg, src)
def _pad(x, pw):
    flat = tuple(v for pair in reversed(pw) for v in pair)
    return torch.nn.functional.pad(x, flat)

kernel_name = 'sequential_preLN__spectral_gfnet__mixer_s_mlp__prompt'

def setup_inputs():

    _w = (lambda a: (lambda t: t.to(torch.bfloat16) if t.is_floating_point() else t)(torch.as_tensor(a)))
    def _A_setup():
        B, S, D = 1, 2048, 640
        Df = D // 2 + 1
        return {
            "x": _w((lambda *s: torch.randn(*s, dtype=torch.bfloat16) * 0.05)(B, S, D)),
            "w_r": _w((lambda *s: torch.randn(*s, dtype=torch.bfloat16) * 0.4)(S, Df) * 0.02),
            "w_i": _w((lambda *s: torch.randn(*s, dtype=torch.bfloat16) * 0.4)(S, Df) * 0.02),
        }
    _A_in = _A_setup()

    def _B_setup():
        B, S, D, F = 1, 2048, 640, 1536
        return {
            "x":  _w((lambda *s: torch.randn(*s, dtype=torch.bfloat16) * 0.05)(B, S, D)),
            "w1": _w((lambda *s: torch.randn(*s, dtype=torch.bfloat16) * 0.8)(D, D) * (D ** -0.5)),
            "w2": _w((lambda *s: torch.randn(*s, dtype=torch.bfloat16) * 0.8)(D, D) * (D ** -0.5)),
            "w3": _w((lambda *s: torch.randn(*s, dtype=torch.bfloat16) * 0.8)(D, F) * (D ** -0.5)),
            "w4": _w((lambda *s: torch.randn(*s, dtype=torch.bfloat16) * 0.8)(F, D) * (F ** -0.5)),
        }
    _B_in = _B_setup()

    return {
        "A_x": _A_in["x"],
        "A_w_r": _A_in["w_r"],
        "A_w_i": _A_in["w_i"],
        "B_x": _B_in["x"],
        "B_w1": _B_in["w1"],
        "B_w2": _B_in["w2"],
        "B_w3": _B_in["w3"],
        "B_w4": _B_in["w4"],
    }

def reference(A_x, A_w_r, A_w_i, B_x, B_w1, B_w2, B_w3, B_w4):
    def _A_ref(x, w_r, w_i):
        B, S, D = x.shape
        X = (lambda x, axes=(-2,-1): torch.fft.rfft2(x.float(), dim=axes))(x, axes=(-2, -1))
        W = w_r + 1j * w_i
        X = X * W
        y = (lambda x, s, axes=(-2,-1): torch.fft.irfft2(x, s=s, dim=axes).to(torch.bfloat16))(X, (S, D), axes=(-2, -1))
        return y

    def _B_ref(x, w1, w2, w3, w4):
        B, S, D = x.shape
        h = _gelu(_layernorm(x, axis=-1) @ w1)
        c = D // 4
        g0 = _pad(h[:, :, 0*c:1*c], ((0, 0), (1, 0), (0, 0)))[:, :S, :]
        g1 = _pad(h[:, :, 1*c:2*c], ((0, 0), (0, 1), (0, 0)))[:, 1:, :]
        g2 = _pad(h[:, :, 2*c:3*c], ((0, 0), (2, 0), (0, 0)))[:, :S, :]
        g3 = _pad(h[:, :, 3*c:   ], ((0, 0), (0, 2), (0, 0)))[:, 2:, :]
        hs = torch.concatenate([g0, g1, g2, g3], axis=-1) @ w2
        x1 = x + hs
        h2 = _gelu(_layernorm(x1, axis=-1) @ w3) @ w4
        return x1 + h2

    x = A_x
    h = x + _A_ref(_layernorm(x, axis=-1), A_w_r, A_w_i)
    h2 = h + _B_ref(_layernorm(h, axis=-1), B_w1, B_w2, B_w3, B_w4)
    return h2
```

```asm
; @launch kernel=net_kernel grid=(256,1,1) block=(256,1,1) lds=163840
.amdgcn_target "amdgcn-amd-amdhsa--gfx950"
.text
.globl net_kernel
.p2align 8
.type net_kernel,@function
net_kernel:
  s_cmp_ge_u32 s2, 256
  s_cbranch_scc1 KM_END
  s_load_dwordx4 s[4:7], s[0:1], 0
  s_load_dwordx2 s[8:9], s[0:1], 16
  s_load_dwordx4 s[48:51], s[0:1], 72
  s_load_dwordx8 s[52:59], s[0:1], 32
FFT_MAIN:
  s_getpc_b64 s[60:61]
PF1:
  v_lshlrev_b32 v254, 7, v0
  v_min_u32 v254, JOIN-PF1, v254
  global_load_dword v255, v254, s[60:61]
  v_and_b32 v1, 15, v0
  v_bfe_u32 v2, v0, 4, 2
  v_and_b32 v3, 63, v0
  v_lshrrev_b32 v9, 6, v0
  s_nop 0
  v_readfirstlane_b32 s3, v9
  v_mul_u32_u24 v67, 320, v2
  v_lshl_add_u32 v67, v1, 2, v67
  v_lshlrev_b32 v4, 4, v3
  s_and_b32 s28, s2, 7
  s_lshr_b32 s29, s2, 3
  s_lshl_b32 s28, s28, 3
  s_lshl_b32 s30, s3, 1
  s_add_u32 s28, s28, s30
  s_lshl_b32 s28, s28, 5
  s_add_u32 s28, s28, s29
  s_mul_i32 s28, s28, 1280
  s_add_u32 s29, s28, 40960
  s_lshr_b32 s31, s2, 2
  s_and_b32 s32, s2, 3
  s_lshl_b32 s32, s32, 3
  s_add_u32 s32, s32, s30
  s_lshl_b32 s32, s32, 6
  s_add_u32 s31, s31, s32
  s_mul_i32 s31, s31, 642
  s_add_u32 s31, s31, 2
  s_add_u32 s32, s31, 41088
  s_cmp_eq_u32 s3, 0
  s_cselect_b32 s62, 0xffff, 0
  s_cselect_b32 s64, 1, 0
  s_mov_b32 s63, 0
  s_mov_b32 s65, 0
  v_mov_b32 v72, 0
  v_mov_b32 v73, 0
  v_mov_b32 v74, 0
  v_mov_b32 v75, 0
  s_lshl_b32 s39, s2, 12
  s_add_u32 s39, s39, 37027840
  s_lshl_b32 s33, s3, 8
  s_add_u32 s33, s33, s2
  s_cmp_lt_u32 s33, 48
  s_cselect_b64 s[46:47], -1, 0
  s_waitcnt lgkmcnt(0)
  s_mov_b32 s12, s4
  s_mov_b32 s13, s5
  s_mov_b32 s14, 2621440
  s_mov_b32 s15, 0x20000
  s_mov_b32 s24, s50
  s_mov_b32 s25, s51
  s_mov_b32 s26, 37486592
  s_mov_b32 s27, 0x20000
  s_mov_b64 exec, s[46:47]
  buffer_store_dwordx4 v[72:75], v4, s[24:27], s39 offen offset:0 sc1
  buffer_store_dwordx4 v[72:75], v4, s[24:27], s39 offen offset:1024 sc1
  buffer_store_dwordx4 v[72:75], v4, s[24:27], s39 offen offset:2048 sc1
  buffer_store_dwordx4 v[72:75], v4, s[24:27], s39 offen offset:3072 sc1
  s_mov_b64 exec, -1
  buffer_load_dword v76, v67, s[12:15], s28 offen offset:0
  buffer_load_dword v77, v67, s[12:15], s28 offen offset:64
  buffer_load_dword v78, v67, s[12:15], s28 offen offset:128
  buffer_load_dword v79, v67, s[12:15], s28 offen offset:192
  buffer_load_dword v80, v67, s[12:15], s28 offen offset:256
  buffer_load_dword v81, v67, s[12:15], s29 offen offset:0
  buffer_load_dword v82, v67, s[12:15], s29 offen offset:64
  buffer_load_dword v83, v67, s[12:15], s29 offen offset:128
  buffer_load_dword v84, v67, s[12:15], s29 offen offset:192
  buffer_load_dword v85, v67, s[12:15], s29 offen offset:256
  s_mov_b32 s16, s6
  s_mov_b32 s17, s7
  s_mov_b32 s18, 1314816
  s_mov_b32 s19, 0x20000
  s_mov_b32 s20, s8
  s_mov_b32 s21, s9
  s_mov_b32 s22, 1314816
  s_mov_b32 s23, 0x20000
  v_cvt_f32_u32 v104, v1
  v_cvt_f32_u32 v106, v2
  v_mul_f32 v105, 0x3e800000, v106
  v_mul_f32 v106, 0x41000000, v106
  v_mul_f32 v105, v105, v104
  v_mul_f32 v106, v106, v104
  v_fmamk_f32 v9, v104, 0x00000000, v105
  v_cos_f32 v164, v9
  v_sin_f32 v172, v9
  v_fmamk_f32 v9, v104, 0x3d4ccccd, v105
  v_cos_f32 v165, v9
  v_sin_f32 v173, v9
  v_fmamk_f32 v9, v104, 0x3dcccccd, v105
  v_cos_f32 v166, v9
  v_sin_f32 v174, v9
  v_fmamk_f32 v9, v104, 0x3e19999a, v105
  v_cos_f32 v167, v9
  v_sin_f32 v175, v9
  v_fmamk_f32 v9, v104, 0x3e4ccccd, v105
  v_cos_f32 v168, v9
  v_sin_f32 v176, v9
  v_cvt_pk_bf16_f32 v108, v164, v165
  v_cvt_pk_bf16_f32 v109, v166, v167
  v_cvt_pk_bf16_f32 v110, v168, 0
  v_mov_b32 v111, 0
  v_cvt_pk_bf16_f32 v112, -v172, -v173
  v_cvt_pk_bf16_f32 v113, -v174, -v175
  v_cvt_pk_bf16_f32 v114, -v176, 0
  v_mov_b32 v115, 0
  v_fmamk_f32 v9, v104, 0x00000000, v106
  v_mul_f32 v10, 0x3acccccd, v9
  v_mul_f32 v9, 0x3d000000, v9
  v_cos_f32 v116, v10
  v_sin_f32 v124, v10
  v_cos_f32 v11, v9
  v_sin_f32 v12, v9
  s_nop 0
  v_cvt_pk_bf16_f32 v132, v11, v12
  v_cvt_pk_bf16_f32 v140, -v12, v11
  v_fmamk_f32 v9, v104, 0x40000000, v106
  v_mul_f32 v10, 0x3acccccd, v9
  v_mul_f32 v9, 0x3d000000, v9
  v_cos_f32 v117, v10
  v_sin_f32 v125, v10
  v_cos_f32 v11, v9
  v_sin_f32 v12, v9
  s_nop 0
  v_cvt_pk_bf16_f32 v133, v11, v12
  v_cvt_pk_bf16_f32 v141, -v12, v11
  v_fmamk_f32 v9, v104, 0x40800000, v106
  v_mul_f32 v10, 0x3acccccd, v9
  v_mul_f32 v9, 0x3d000000, v9
  v_cos_f32 v118, v10
  v_sin_f32 v126, v10
  v_cos_f32 v11, v9
  v_sin_f32 v12, v9
  s_nop 0
  v_cvt_pk_bf16_f32 v134, v11, v12
  v_cvt_pk_bf16_f32 v142, -v12, v11
  v_fmamk_f32 v9, v104, 0x40c00000, v106
  v_mul_f32 v10, 0x3acccccd, v9
  v_mul_f32 v9, 0x3d000000, v9
  v_cos_f32 v119, v10
  v_sin_f32 v127, v10
  v_cos_f32 v11, v9
  v_sin_f32 v12, v9
  s_nop 0
  v_cvt_pk_bf16_f32 v135, v11, v12
  v_cvt_pk_bf16_f32 v143, -v12, v11
  v_fmamk_f32 v9, v104, 0x3f800000, v106
  v_mul_f32 v10, 0x3acccccd, v9
  v_mul_f32 v9, 0x3d000000, v9
  v_cos_f32 v120, v10
  v_sin_f32 v128, v10
  v_cos_f32 v11, v9
  v_sin_f32 v12, v9
  s_nop 0
  v_cvt_pk_bf16_f32 v136, v11, v12
  v_cvt_pk_bf16_f32 v144, -v12, v11
  v_fmamk_f32 v9, v104, 0x40400000, v106
  v_mul_f32 v10, 0x3acccccd, v9
  v_mul_f32 v9, 0x3d000000, v9
  v_cos_f32 v121, v10
  v_sin_f32 v129, v10
  v_cos_f32 v11, v9
  v_sin_f32 v12, v9
  s_nop 0
  v_cvt_pk_bf16_f32 v137, v11, v12
  v_cvt_pk_bf16_f32 v145, -v12, v11
  v_fmamk_f32 v9, v104, 0x40a00000, v106
  v_mul_f32 v10, 0x3acccccd, v9
  v_mul_f32 v9, 0x3d000000, v9
  v_cos_f32 v122, v10
  v_sin_f32 v130, v10
  v_cos_f32 v11, v9
  v_sin_f32 v12, v9
  s_nop 0
  v_cvt_pk_bf16_f32 v138, v11, v12
  v_cvt_pk_bf16_f32 v146, -v12, v11
  v_fmamk_f32 v9, v104, 0x40e00000, v106
  v_mul_f32 v10, 0x3acccccd, v9
  v_mul_f32 v9, 0x3d000000, v9
  v_cos_f32 v123, v10
  v_sin_f32 v131, v10
  v_cos_f32 v11, v9
  v_sin_f32 v12, v9
  s_nop 0
  v_cvt_pk_bf16_f32 v139, v11, v12
  v_cvt_pk_bf16_f32 v147, -v12, v11
  s_mul_i32 s33, s3, 5632
  s_lshr_b32 s34, s3, 1
  s_lshl_b32 s34, s34, 6
  s_add_u32 s33, s33, s34
  s_add_u32 s33, s33, 12
  v_add_u32 v196, s33, v67
  s_add_u32 s34, s33, 1040
  v_sub_u32 v197, s34, v67
  s_add_u32 s34, s33, 1284
  v_lshl_add_u32 v198, v3, 5, s34
  v_lshlrev_b32 v199, 4, v0
  s_lshr_b32 s35, s2, 1
  s_mul_i32 s35, s35, 61440
  s_bitcmp1_b32 s2, 0
  s_cselect_b32 s34, 40960, 0
  s_add_u32 s35, s35, s34
  s_mov_b32 s36, 0x05040100
  s_mov_b32 s37, 0x07060302
  s_mov_b32 s38, 0x3f803f80
  v_cmp_eq_u32 vcc, 0, v1
  v_mov_b32 v9, 0xbd000000
  s_nop 0
  v_cndmask_b32 v200, 0, v9, vcc
  v_cmp_eq_u32 vcc, 0, v3
  s_nop 1
  v_cndmask_b32 v201, 1.0, 0.5, vcc
  v_and_b32 v9, 1, v0
  v_mul_u32_u24 v9, 11328, v9
  v_bfe_u32 v10, v0, 1, 1
  v_mul_u32_u24 v10, 160, v10
  v_add3_u32 v9, v9, v10, 16
  v_lshrrev_b32 v10, 2, v0
  v_add_u32 v11, 0, v10
  v_mul_u32_u24 v12, 1639, v11
  v_lshrrev_b32 v12, 16, v12
  v_mul_u32_u24 v12, 40, v12
  v_add_u32 v11, v11, v12
  v_lshl_add_u32 v202, v11, 2, v9
  v_add_u32 v11, 64, v10
  v_mul_u32_u24 v12, 1639, v11
  v_lshrrev_b32 v12, 16, v12
  v_mul_u32_u24 v12, 40, v12
  v_add_u32 v11, v11, v12
  v_lshl_add_u32 v203, v11, 2, v9
  v_add_u32 v11, 128, v10
  v_mul_u32_u24 v12, 1639, v11
  v_lshrrev_b32 v12, 16, v12
  v_mul_u32_u24 v12, 40, v12
  v_add_u32 v11, v11, v12
  v_lshl_add_u32 v204, v11, 2, v9
  v_add_u32 v11, 192, v10
  v_mul_u32_u24 v12, 1639, v11
  v_lshrrev_b32 v12, 16, v12
  v_mul_u32_u24 v12, 40, v12
  v_add_u32 v11, v11, v12
  v_lshl_add_u32 v205, v11, 2, v9
  v_add_u32 v11, 256, v10
  v_mul_u32_u24 v12, 1639, v11
  v_lshrrev_b32 v12, 16, v12
  v_mul_u32_u24 v12, 40, v12
  v_add_u32 v11, v11, v12
  v_lshl_add_u32 v206, v11, 2, v9
  v_mov_b32 v5, 1
  s_and_b32 s33, s2, 15
  s_lshl_b32 s33, s33, 7
  v_lshl_add_u32 v6, v1, 11, s33
  v_lshlrev_b32 v8, 7, v1
  s_lshr_b32 s34, s2, 4
  s_lshl_b32 s34, s34, 11
  v_add_u32 v7, s34, v8
  s_waitcnt vmcnt(10)
  s_and_b32 s46, s46, 1
  s_mov_b32 s47, 0
  s_mov_b64 exec, s[46:47]
  global_atomic_add v72, v5, s[48:49] sc1
  s_mov_b64 exec, -1
  s_mov_b32 exec_hi, 0xff
  buffer_load_dwordx4 v[88:91], v4, s[16:19], s31 offen nt
  buffer_load_dwordx4 v[96:99], v4, s[20:23], s31 offen nt
  buffer_load_dwordx4 v[92:95], v4, s[16:19], s32 offen nt
  buffer_load_dwordx4 v[100:103], v4, s[20:23], s32 offen nt
  s_mov_b64 exec, -1
  s_lshr_b32 s33, s3, 1
  s_and_b32 s34, s3, 1
  s_lshl_b32 s33, s33, 5
  s_lshl_b32 s34, s34, 2
  s_add_u32 s69, s33, s34
  v_lshrrev_b32 v9, 2, v1
  v_and_b32 v10, 3, v1
  v_lshl_add_u32 v9, v9, 3, v10
  v_add_u32 v9, s69, v9
  v_cvt_f32_u32 v65, v9
  v_lshlrev_b32 v9, 3, v2
  v_cvt_f32_u32 v64, v9
  v_mul_f32 v65, 0x3c800000, v65
  v_mul_f32 v66, v65, v64
  v_fmamk_f32 v9, v65, 0x00000000, v66
  v_cos_f32 v11, v9
  v_sin_f32 v12, v9
  s_nop 0
  v_cvt_pk_bf16_f32 v16, v11, v12
  v_cvt_pk_bf16_f32 v32, -v12, v11
  v_fmamk_f32 v9, v65, 0x3f800000, v66
  v_cos_f32 v11, v9
  v_sin_f32 v12, v9
  s_nop 0
  v_cvt_pk_bf16_f32 v17, v11, v12
  v_cvt_pk_bf16_f32 v33, -v12, v11
  v_fmamk_f32 v9, v65, 0x40000000, v66
  v_cos_f32 v11, v9
  v_sin_f32 v12, v9
  s_nop 0
  v_cvt_pk_bf16_f32 v18, v11, v12
  v_cvt_pk_bf16_f32 v34, -v12, v11
  v_fmamk_f32 v9, v65, 0x40400000, v66
  v_cos_f32 v11, v9
  v_sin_f32 v12, v9
  s_nop 0
  v_cvt_pk_bf16_f32 v19, v11, v12
  v_cvt_pk_bf16_f32 v35, -v12, v11
  v_fmamk_f32 v9, v65, 0x40800000, v66
  v_cos_f32 v11, v9
  v_sin_f32 v12, v9
  s_nop 0
  v_cvt_pk_bf16_f32 v20, v11, v12
  v_cvt_pk_bf16_f32 v36, -v12, v11
  v_fmamk_f32 v9, v65, 0x40a00000, v66
  v_cos_f32 v11, v9
  v_sin_f32 v12, v9
  s_nop 0
  v_cvt_pk_bf16_f32 v21, v11, v12
  v_cvt_pk_bf16_f32 v37, -v12, v11
  v_fmamk_f32 v9, v65, 0x40c00000, v66
  v_cos_f32 v11, v9
  v_sin_f32 v12, v9
  s_nop 0
  v_cvt_pk_bf16_f32 v22, v11, v12
  v_cvt_pk_bf16_f32 v38, -v12, v11
  v_fmamk_f32 v9, v65, 0x40e00000, v66
  v_cos_f32 v11, v9
  v_sin_f32 v12, v9
  s_nop 0
  v_cvt_pk_bf16_f32 v23, v11, v12
  v_cvt_pk_bf16_f32 v39, -v12, v11
  v_mov_b32 v151, 0
  v_mov_b32 v155, 0
  v_mov_b32 v207, 0
  v_mov_b32 v209, 0
  v_mov_b32 v159, 0
  v_mov_b32 v163, 0
  v_mov_b32 v208, 0
  v_mov_b32 v210, 0
  s_waitcnt vmcnt(14)
  v_dot2c_f32_bf16 v207, s38, v76
  v_dot2c_f32_bf16 v209, v76, v76
  s_waitcnt vmcnt(9)
  v_dot2c_f32_bf16 v208, s38, v81
  v_dot2c_f32_bf16 v210, v81, v81
  v_dot2c_f32_bf16 v207, s38, v77
  v_dot2c_f32_bf16 v209, v77, v77
  s_waitcnt vmcnt(8)
  v_dot2c_f32_bf16 v208, s38, v82
  v_dot2c_f32_bf16 v210, v82, v82
  v_dot2c_f32_bf16 v207, s38, v78
  v_dot2c_f32_bf16 v209, v78, v78
  s_waitcnt vmcnt(7)
  v_dot2c_f32_bf16 v208, s38, v83
  v_dot2c_f32_bf16 v210, v83, v83
  v_dot2c_f32_bf16 v207, s38, v79
  v_dot2c_f32_bf16 v209, v79, v79
  s_waitcnt vmcnt(6)
  v_dot2c_f32_bf16 v208, s38, v84
  v_dot2c_f32_bf16 v210, v84, v84
  v_dot2c_f32_bf16 v207, s38, v80
  v_dot2c_f32_bf16 v209, v80, v80
  s_waitcnt vmcnt(5)
  v_dot2c_f32_bf16 v208, s38, v85
  v_dot2c_f32_bf16 v210, v85, v85
  v_perm_b32 v148, v77, v76, s36
  v_permlane16_swap_b32 v207, v209
  v_add_f32 v207, v207, v209
  v_permlane16_swap_b32 v208, v210
  v_add_f32 v208, v208, v210
  v_perm_b32 v149, v79, v78, s36
  v_and_b32 v150, 0xffff, v80
  v_permlane32_swap_b32 v207, v208
  v_add_f32 v207, v207, v208
  v_perm_b32 v152, v77, v76, s37
  v_perm_b32 v153, v79, v78, s37
  v_add_f32_dpp v207, v207, v207 row_ror:8 row_mask:0xf bank_mask:0xf
  v_lshrrev_b32 v154, 16, v80
  v_mfma_f32_16x16x32_bf16 v[168:171], v[148:151], v[112:115], 0
  v_add_f32_dpp v207, v207, v207 row_ror:4 row_mask:0xf bank_mask:0xf
  v_perm_b32 v156, v82, v81, s36
  v_perm_b32 v157, v84, v83, s36
  v_and_b32 v158, 0xffff, v85
  v_add_f32_dpp v207, v207, v207 row_ror:2 row_mask:0xf bank_mask:0xf
  v_mfma_f32_16x16x32_bf16 v[164:167], v[148:151], v[108:111], 0
  v_perm_b32 v160, v82, v81, s37
  v_perm_b32 v161, v84, v83, s37
  v_mfma_f32_16x16x32_bf16 v[176:179], v[152:155], v[112:115], 0
  v_lshrrev_b32 v162, 16, v85
  v_add_f32_dpp v207, v207, v207 row_ror:1 row_mask:0xf bank_mask:0xf
  v_mfma_f32_16x16x32_bf16 v[172:175], v[152:155], v[108:111], 0
  v_readlane_b32 s40, v207, 0
  v_readlane_b32 s42, v207, 32
  v_mfma_f32_16x16x32_bf16 v[184:187], v[156:159], v[112:115], 0
  v_mul_f32 v212, s40, v200
  v_mul_f32 v214, s42, v200
  v_mfma_f32_16x16x32_bf16 v[180:183], v[156:159], v[108:111], 0
  v_readlane_b32 s41, v207, 16
  v_readlane_b32 s43, v207, 48
  v_mfma_f32_16x16x32_bf16 v[192:195], v[160:163], v[112:115], 0
  v_mov_b32 v9, 0x3acccccd
  v_mov_b32 v10, 0x3acccccd
  v_mfma_f32_16x16x32_bf16 v[188:191], v[160:163], v[108:111], 0
  v_mul_f32 v11, s40, v9
  v_mul_f32 v12, s42, v10
  v_mul_f32 v9, s41, v9
  v_mul_f32 v10, s43, v10
  v_fma_f32 v9, -v11, v11, v9
  v_pk_fma_f32 v[236:237], v[168:169], v[124:125], v[212:213] op_sel_hi:[1,1,0]
  v_pk_mul_f32 v[240:241], v[168:169], v[116:117]
  v_pk_fma_f32 v[238:239], v[170:171], v[126:127], v[212:213] op_sel_hi:[1,1,0]
  v_pk_mul_f32 v[242:243], v[170:171], v[118:119]
  v_pk_fma_f32 v[236:237], v[164:165], v[116:117], v[236:237]
  v_pk_fma_f32 v[240:241], v[164:165], v[124:125], v[240:241] neg_lo:[1,0,0] neg_hi:[1,0,0]
  v_pk_fma_f32 v[238:239], v[166:167], v[118:119], v[238:239]
  v_pk_fma_f32 v[242:243], v[166:167], v[126:127], v[242:243] neg_lo:[1,0,0] neg_hi:[1,0,0]
  v_pk_fma_f32 v[244:245], v[176:177], v[128:129], v[212:213] op_sel_hi:[1,1,0]
  v_pk_mul_f32 v[248:249], v[176:177], v[120:121]
  v_pk_fma_f32 v[246:247], v[178:179], v[130:131], v[212:213] op_sel_hi:[1,1,0]
  v_pk_mul_f32 v[250:251], v[178:179], v[122:123]
  v_cvt_pk_bf16_f32 v220, v236, v240
  v_cvt_pk_bf16_f32 v221, v237, v241
  v_cvt_pk_bf16_f32 v222, v238, v242
  v_cvt_pk_bf16_f32 v223, v239, v243
  v_pk_fma_f32 v[244:245], v[172:173], v[120:121], v[244:245]
  v_pk_fma_f32 v[248:249], v[172:173], v[128:129], v[248:249] neg_lo:[1,0,0] neg_hi:[1,0,0]
  v_pk_fma_f32 v[246:247], v[174:175], v[122:123], v[246:247]
  v_pk_fma_f32 v[250:251], v[174:175], v[130:131], v[250:251] neg_lo:[1,0,0] neg_hi:[1,0,0]
  v_cvt_pk_bf16_f32 v224, v244, v248
  v_cvt_pk_bf16_f32 v225, v245, v249
  v_cvt_pk_bf16_f32 v226, v246, v250
  v_cvt_pk_bf16_f32 v227, v247, v251
  v_pk_fma_f32 v[236:237], v[184:185], v[124:125], v[214:215] op_sel_hi:[1,1,0]
  v_pk_mul_f32 v[240:241], v[184:185], v[116:117]
  v_pk_fma_f32 v[238:239], v[186:187], v[126:127], v[214:215] op_sel_hi:[1,1,0]
  v_pk_mul_f32 v[242:243], v[186:187], v[118:119]
  v_pk_fma_f32 v[236:237], v[180:181], v[116:117], v[236:237]
  v_pk_fma_f32 v[240:241], v[180:181], v[124:125], v[240:241] neg_lo:[1,0,0] neg_hi:[1,0,0]
  v_pk_fma_f32 v[238:239], v[182:183], v[118:119], v[238:239]
  v_pk_fma_f32 v[242:243], v[182:183], v[126:127], v[242:243] neg_lo:[1,0,0] neg_hi:[1,0,0]
  v_pk_fma_f32 v[244:245], v[192:193], v[128:129], v[214:215] op_sel_hi:[1,1,0]
  v_pk_mul_f32 v[248:249], v[192:193], v[120:121]
  v_pk_fma_f32 v[246:247], v[194:195], v[130:131], v[214:215] op_sel_hi:[1,1,0]
  v_pk_mul_f32 v[250:251], v[194:195], v[122:123]
  v_cvt_pk_bf16_f32 v228, v236, v240
  v_cvt_pk_bf16_f32 v229, v237, v241
  v_cvt_pk_bf16_f32 v230, v238, v242
  v_cvt_pk_bf16_f32 v231, v239, v243
  v_pk_fma_f32 v[244:245], v[188:189], v[120:121], v[244:245]
  v_pk_fma_f32 v[248:249], v[188:189], v[128:129], v[248:249] neg_lo:[1,0,0] neg_hi:[1,0,0]
  v_pk_fma_f32 v[246:247], v[190:191], v[122:123], v[246:247]
  v_pk_fma_f32 v[250:251], v[190:191], v[130:131], v[250:251] neg_lo:[1,0,0] neg_hi:[1,0,0]
  v_cvt_pk_bf16_f32 v232, v244, v248
  v_cvt_pk_bf16_f32 v233, v245, v249
  v_cvt_pk_bf16_f32 v234, v246, v250
  v_cvt_pk_bf16_f32 v235, v247, v251
  v_mfma_f32_16x16x32_bf16 v[148:151], v[132:135], v[220:223], 0
  v_fma_f32 v10, -v12, v12, v10
  v_max_f32 v9, 0, v9
  v_mfma_f32_16x16x32_bf16 v[168:171], v[140:143], v[220:223], 0
  v_max_f32 v10, 0, v10
  v_add_f32 v9, 0x3727c5ac, v9
  v_mfma_f32_16x16x32_bf16 v[156:159], v[132:135], v[228:231], 0
  v_add_f32 v10, 0x3727c5ac, v10
  v_rsq_f32 v216, v9
  v_mfma_f32_16x16x32_bf16 v[184:187], v[140:143], v[228:231], 0
  v_rsq_f32 v218, v10
  v_mfma_f32_16x16x32_bf16 v[152:155], v[136:139], v[224:227], 0
  s_mov_b32 s44, 0x07ff07ff
  s_mov_b32 s45, 0x07ff07ff
  v_mfma_f32_16x16x32_bf16 v[176:179], v[144:147], v[224:227], 0
  v_mfma_f32_16x16x32_bf16 v[160:163], v[136:139], v[232:235], 0
  v_mfma_f32_16x16x32_bf16 v[192:195], v[144:147], v[232:235], 0
  v_pk_mul_f32 v[148:149], v[148:149], v[216:217] op_sel_hi:[1,0]
  v_pk_mul_f32 v[236:237], v[168:169], v[216:217] op_sel_hi:[1,0]
  v_pk_mul_f32 v[238:239], v[170:171], v[216:217] op_sel_hi:[1,0]
  v_pk_mul_f32 v[156:157], v[156:157], v[218:219] op_sel_hi:[1,0]
  v_pk_mul_f32 v[244:245], v[184:185], v[218:219] op_sel_hi:[1,0]
  v_pk_mul_f32 v[246:247], v[186:187], v[218:219] op_sel_hi:[1,0]
  v_pk_fma_f32 v[172:173], v[152:153], v[216:217], v[148:149] op_sel_hi:[1,0,1] neg_lo:[1,0,0] neg_hi:[1,0,0]
  v_pk_mul_f32 v[150:151], v[150:151], v[216:217] op_sel_hi:[1,0]
  v_pk_fma_f32 v[168:169], v[176:177], v[216:217], v[236:237] op_sel_hi:[1,0,1]
  v_pk_fma_f32 v[170:171], v[178:179], v[216:217], v[238:239] op_sel_hi:[1,0,1]
  v_pk_fma_f32 v[188:189], v[160:161], v[218:219], v[156:157] op_sel_hi:[1,0,1] neg_lo:[1,0,0] neg_hi:[1,0,0]
  v_pk_mul_f32 v[158:159], v[158:159], v[218:219] op_sel_hi:[1,0]
  v_pk_fma_f32 v[184:185], v[192:193], v[218:219], v[244:245] op_sel_hi:[1,0,1]
  v_pk_fma_f32 v[186:187], v[194:195], v[218:219], v[246:247] op_sel_hi:[1,0,1]
  v_pk_fma_f32 v[164:165], v[152:153], v[216:217], v[148:149] op_sel_hi:[1,0,1]
  v_pk_fma_f32 v[166:167], v[154:155], v[216:217], v[150:151] op_sel_hi:[1,0,1]
  v_pk_fma_f32 v[174:175], v[154:155], v[216:217], v[150:151] op_sel_hi:[1,0,1] neg_lo:[1,0,0] neg_hi:[1,0,0]
  v_pk_fma_f32 v[176:177], v[176:177], v[216:217], v[236:237] op_sel_hi:[1,0,1] neg_lo:[1,0,0] neg_hi:[1,0,0]
  v_pk_fma_f32 v[178:179], v[178:179], v[216:217], v[238:239] op_sel_hi:[1,0,1] neg_lo:[1,0,0] neg_hi:[1,0,0]
  v_mul_f32 v172, v172, v201
  v_pk_fma_f32 v[180:181], v[160:161], v[218:219], v[156:157] op_sel_hi:[1,0,1]
  v_pk_fma_f32 v[182:183], v[162:163], v[218:219], v[158:159] op_sel_hi:[1,0,1]
  v_pk_fma_f32 v[190:191], v[162:163], v[218:219], v[158:159] op_sel_hi:[1,0,1] neg_lo:[1,0,0] neg_hi:[1,0,0]
  v_pk_fma_f32 v[192:193], v[192:193], v[218:219], v[244:245] op_sel_hi:[1,0,1] neg_lo:[1,0,0] neg_hi:[1,0,0]
  v_pk_fma_f32 v[194:195], v[194:195], v[218:219], v[246:247] op_sel_hi:[1,0,1] neg_lo:[1,0,0] neg_hi:[1,0,0]
  v_mul_f32 v188, v188, v201
  v_cvt_pk_bf16_f32 v220, v164, v168
  v_cvt_pk_bf16_f32 v224, v172, -v176
  v_cvt_pk_bf16_f32 v221, v165, v169
  v_cvt_pk_bf16_f32 v225, v173, -v177
  v_cvt_pk_bf16_f32 v222, v166, v170
  v_cvt_pk_bf16_f32 v226, v174, -v178
  v_cvt_pk_bf16_f32 v223, v167, v171
  v_cvt_pk_bf16_f32 v227, v175, -v179
  v_cvt_pk_bf16_f32 v228, v180, v184
  v_cvt_pk_bf16_f32 v232, v188, -v192
  v_cvt_pk_bf16_f32 v229, v181, v185
  v_cvt_pk_bf16_f32 v233, v189, -v193
  v_cvt_pk_bf16_f32 v230, v182, v186
  v_cvt_pk_bf16_f32 v234, v190, -v194
  v_cvt_pk_bf16_f32 v231, v183, v187
  v_cvt_pk_bf16_f32 v235, v191, -v195
  s_mov_b64 exec, s[44:45]
  ds_write_b32 v196, v220 offset:0
  ds_write_b32 v197, v224 offset:240
  ds_write_b32 v196, v221 offset:80
  ds_write_b32 v197, v225 offset:160
  ds_write_b32 v196, v222 offset:160
  ds_write_b32 v197, v226 offset:80
  ds_write_b32 v196, v223 offset:240
  ds_write_b32 v197, v227 offset:0
  ds_write_b32 v196, v228 offset:2816
  ds_write_b32 v197, v232 offset:3056
  ds_write_b32 v196, v229 offset:2896
  ds_write_b32 v197, v233 offset:2976
  ds_write_b32 v196, v230 offset:2976
  ds_write_b32 v197, v234 offset:2896
  ds_write_b32 v196, v231 offset:3056
  ds_write_b32 v197, v235 offset:2816
  s_mov_b32 exec_lo, -1
  s_mov_b32 exec_hi, 0xff
  s_waitcnt vmcnt(0)
  v_perm_b32 v164, v96, v88, s36
  v_perm_b32 v165, v96, v88, s37
  v_perm_b32 v166, v97, v89, s36
  v_perm_b32 v167, v97, v89, s37
  v_perm_b32 v168, v98, v90, s36
  v_perm_b32 v169, v98, v90, s37
  v_perm_b32 v170, v99, v91, s36
  v_perm_b32 v171, v99, v91, s37
  ds_write_b128 v198, v[164:167] offset:0
  ds_write_b128 v198, v[168:171] offset:16
  v_perm_b32 v172, v100, v92, s36
  v_perm_b32 v173, v100, v92, s37
  v_perm_b32 v174, v101, v93, s36
  v_perm_b32 v175, v101, v93, s37
  v_perm_b32 v176, v102, v94, s36
  v_perm_b32 v177, v102, v94, s37
  v_perm_b32 v178, v103, v95, s36
  v_perm_b32 v179, v103, v95, s37
  ds_write_b128 v198, v[172:175] offset:2816
  ds_write_b128 v198, v[176:179] offset:2832
  s_mov_b64 exec, -1
  v_mov_b32 v72, 0
  s_waitcnt lgkmcnt(0)
  s_barrier
  ds_read2st64_b32 v[164:165], v202 offset0:0 offset1:11
  ds_read2st64_b32 v[166:167], v202 offset0:22 offset1:33
  ds_read2st64_b32 v[168:169], v203 offset0:0 offset1:11
  ds_read2st64_b32 v[170:171], v203 offset0:22 offset1:33
  ds_read2st64_b32 v[172:173], v204 offset0:0 offset1:11
  ds_read2st64_b32 v[174:175], v204 offset0:22 offset1:33
  ds_read2st64_b32 v[176:177], v205 offset0:0 offset1:11
  ds_read2st64_b32 v[178:179], v205 offset0:22 offset1:33
  ds_read2st64_b32 v[180:181], v206 offset0:0 offset1:11
  ds_read2st64_b32 v[182:183], v206 offset0:22 offset1:33
  global_load_dword v73, v72, s[48:49] sc1
  s_waitcnt lgkmcnt(5)
  buffer_store_dwordx4 v[164:167], v199, s[24:27], s35 offen sc1
  s_add_u32 s35, s35, 4096
  buffer_store_dwordx4 v[168:171], v199, s[24:27], s35 offen sc1
  s_add_u32 s35, s35, 4096
  s_waitcnt lgkmcnt(4)
  buffer_store_dwordx4 v[172:175], v199, s[24:27], s35 offen sc1
  s_add_u32 s35, s35, 4096
  s_waitcnt lgkmcnt(2)
  buffer_store_dwordx4 v[176:179], v199, s[24:27], s35 offen sc1
  s_add_u32 s35, s35, 4096
  s_waitcnt lgkmcnt(0)
  buffer_store_dwordx4 v[180:183], v199, s[24:27], s35 offen sc1
  s_nop 4
  s_cmp_ge_u32 s2, 160
  s_cbranch_scc1 SET_B
  v_and_b32 v9, 3, v0
  v_xor_b32 v9, v9, v2
  v_lshlrev_b32 v9, 4, v9
  v_lshrrev_b32 v10, 2, v3
  s_mov_b32 s28, 491520
  v_mad_u32_u24 v75, v10, s28, v9
  v_and_b32 v10, 3, v10
  v_lshl_add_u32 v10, v2, 3, v10
  s_mov_b32 s28, 122880
  v_mad_u32_u24 v76, v10, s28, v9
  s_and_b32 s28, s2, 7
  s_mul_i32 s28, s28, 20
  s_lshr_b32 s29, s2, 3
  s_add_u32 s28, s28, s29
  s_lshl_b32 s29, s28, 6
  s_mul_i32 s30, s3, 122880
  s_add_u32 s30, s30, s29
  s_mul_i32 s34, s69, 122880
  s_add_u32 s34, s34, s29
  s_add_u32 s34, s34, 10240
  s_lshl_b32 s38, s3, 12
  s_mov_b32 s47, 37151232
  v_fmamk_f32 v9, v65, 0x42000000, v66
  v_cos_f32 v11, v9
  v_sin_f32 v12, v9
  s_nop 0
  v_cvt_pk_bf16_f32 v24, v11, v12
  v_cvt_pk_bf16_f32 v40, -v12, v11
  v_fmamk_f32 v9, v65, 0x42040000, v66
  v_cos_f32 v11, v9
  v_sin_f32 v12, v9
  s_nop 0
  v_cvt_pk_bf16_f32 v25, v11, v12
  v_cvt_pk_bf16_f32 v41, -v12, v11
  v_fmamk_f32 v9, v65, 0x42080000, v66
  v_cos_f32 v11, v9
  v_sin_f32 v12, v9
  s_nop 0
  v_cvt_pk_bf16_f32 v26, v11, v12
  v_cvt_pk_bf16_f32 v42, -v12, v11
  v_fmamk_f32 v9, v65, 0x420c0000, v66
  v_cos_f32 v11, v9
  v_sin_f32 v12, v9
  s_nop 0
  v_cvt_pk_bf16_f32 v27, v11, v12
  v_cvt_pk_bf16_f32 v43, -v12, v11
  v_fmamk_f32 v9, v65, 0x42100000, v66
  v_cos_f32 v11, v9
  v_sin_f32 v12, v9
  s_nop 0
  v_cvt_pk_bf16_f32 v28, v11, v12
  v_cvt_pk_bf16_f32 v44, -v12, v11
  v_fmamk_f32 v9, v65, 0x42140000, v66
  v_cos_f32 v11, v9
  v_sin_f32 v12, v9
  s_nop 0
  v_cvt_pk_bf16_f32 v29, v11, v12
  v_cvt_pk_bf16_f32 v45, -v12, v11
  v_fmamk_f32 v9, v65, 0x42180000, v66
  v_cos_f32 v11, v9
  v_sin_f32 v12, v9
  s_nop 0
  v_cvt_pk_bf16_f32 v30, v11, v12
  v_cvt_pk_bf16_f32 v46, -v12, v11
  v_fmamk_f32 v9, v65, 0x421c0000, v66
  v_cos_f32 v11, v9
  v_sin_f32 v12, v9
  s_nop 0
  v_cvt_pk_bf16_f32 v31, v11, v12
  v_cvt_pk_bf16_f32 v47, -v12, v11
  v_mul_f32 v65, 0x3d000000, v65
  v_mul_f32 v66, 0x3d000000, v66
  v_fmamk_f32 v9, v65, 0x00000000, v66
  v_cos_f32 v48, v9
  v_sin_f32 v56, v9
  v_fmamk_f32 v9, v65, 0x40000000, v66
  v_cos_f32 v49, v9
  v_sin_f32 v57, v9
  v_fmamk_f32 v9, v65, 0x40800000, v66
  v_cos_f32 v50, v9
  v_sin_f32 v58, v9
  v_fmamk_f32 v9, v65, 0x40c00000, v66
  v_cos_f32 v51, v9
  v_sin_f32 v59, v9
  v_fmamk_f32 v9, v65, 0x3f800000, v66
  v_cos_f32 v52, v9
  v_sin_f32 v60, v9
  v_fmamk_f32 v9, v65, 0x40400000, v66
  v_cos_f32 v53, v9
  v_sin_f32 v61, v9
  v_fmamk_f32 v9, v65, 0x40a00000, v66
  v_cos_f32 v54, v9
  v_sin_f32 v62, v9
  v_fmamk_f32 v9, v65, 0x40e00000, v66
  v_cos_f32 v55, v9
  v_sin_f32 v63, v9
  s_branch SET_END
SET_B:
  s_mul_i32 s64, s3, 5184
  s_mul_i32 s65, s3, 6208
  s_mul_i32 s31, s3, 10240
  s_sub_u32 s11, s2, 160
  s_and_b32 s28, s11, 1
  s_lshr_b32 s29, s11, 1
  s_mul_i32 s66, s29, 40960
  s_mul_i32 s32, s28, 640
  s_add_u32 s32, s32, s31
  s_add_u32 s66, s66, s32
  s_lshl_b32 s30, s28, 2
  s_add_u32 s30, s30, s3
  s_mul_i32 s33, s29, 43
  s_lshr_b32 s33, s33, 7
  s_lshl_b32 s67, s29, 4
  s_mul_i32 s33, s33, 47
  s_sub_u32 s33, s67, s33
  s_mul_i32 s67, s30, 48
  s_add_u32 s67, s67, s33
  s_mul_i32 s67, s67, 5120
  s_add_u32 s67, s67, 35061760
  s_cmp_ge_u32 s11, 80
  s_cselect_b32 s33, 16, 0
  s_cselect_b32 s68, 0, 0xffff
  s_sub_u32 s11, s11, s33
  s_cmp_ge_u32 s11, 40
  s_cselect_b32 s16, s54, s52
  s_cselect_b32 s17, s55, s53
  s_cselect_b32 s20, 819200, 0
  s_cselect_b32 s33, 40, 0
  s_cselect_b32 s10, 0, 0xffff
  s_mov_b32 s18, 819200
  s_sub_u32 s33, s11, s33
  s_lshr_b32 s29, s33, 1
  s_mul_i32 s21, s29, 40960
  s_add_u32 s21, s21, s32
  s_mul_i32 s46, s30, 20
  s_add_u32 s46, s46, s29
  s_mul_i32 s46, s46, 5120
  s_add_u32 s46, s46, s20
  s_add_u32 s46, s46, 31457280
  s_mul_i32 s47, s30, 320
  s_add_u32 s47, s47, 37027840
  s_mov_b32 s4, s56
  s_mov_b32 s5, s57
  s_mov_b32 s6, 1966080
  s_mov_b32 s7, 0x20000
  s_and_b32 s28, s11, 3
  s_lshr_b32 s29, s11, 2
  s_lshl_b32 s32, s29, 2
  s_add_u32 s32, s32, s3
  s_mul_i32 s20, s32, 24576
  s_mul_i32 s33, s28, 768
  s_add_u32 s20, s20, s33
  s_lshl_b32 s32, s28, 2
  s_add_u32 s32, s32, s3
  s_mul_i32 s8, s32, 30
  s_add_u32 s8, s8, s29
  s_lshl_b32 s8, s8, 12
  s_lshl_b32 s69, s29, 11
  s_sub_u32 s69, 81920, s69
  s_add_u32 s8, s8, 33095680
  s_mul_i32 s9, s32, 384
  s_add_u32 s9, s9, 37030400
  s_and_b32 s30, s3, 1
  s_lshr_b32 s31, s3, 1
  s_mul_i32 s31, s31, 320
  v_mul_u32_u24 v76, 5184, v2
  v_add_u32 v76, s31, v76
  v_lshl_add_u32 v75, v1, 2, v76
  v_lshl_add_u32 v76, v1, 1, v76
  s_lshl_b32 s34, s30, 5
  s_add_u32 s34, s34, 128
  v_add_u32 v76, s34, v76
  s_mul_i32 s34, s30, 192
  v_add_u32 v75, s34, v75
  s_mul_i32 s34, s3, 192
  s_add_u32 s34, s34, 57344
  v_mul_u32_u24 v77, 6208, v2
  v_lshl_add_u32 v77, v1, 2, v77
  v_add_u32 v77, s34, v77
  v_mov_b32 v80, 0x3f803f80
  v_mov_b32 v81, 0x3f803f80
  v_mov_b32 v82, 0x3f803f80
  v_mov_b32 v83, 0x3f803f80
  v_lshlrev_b32 v78, 2, v1
SET_END:
  s_nop 4
  s_waitcnt vmcnt(5)
  v_cmp_gt_u32 vcc, 48, v73
  s_nop 4
  s_cbranch_vccz CLR1_OUT
  s_movk_i32 s22, 0x7fff
CLR1:
  global_load_dword v73, v72, s[48:49] sc1
  s_waitcnt vmcnt(0)
  v_cmp_gt_u32 vcc, 48, v73
  s_sub_u32 s22, s22, 1
  s_cbranch_scc1 CLR1_OUT
  s_cbranch_vccnz CLR1
CLR1_OUT:
  s_nop 4
  s_mov_b32 s23, 37085696
  s_waitcnt vmcnt(0)
  s_barrier
  s_mov_b64 exec, s[62:63]
  buffer_atomic_add v5, v6, s[24:27], s23 offen sc1
  s_mov_b64 exec, -1
  s_mov_b32 s45, s2
  s_cmp_lt_u32 s2, 160
  s_cbranch_scc1 FFT_COLS
  s_mov_b32 exec_hi, 255
  s_add_u32 m0, s64, 32768
  s_nop 0
  buffer_load_dwordx4 v4, s[16:19], s21 offen nt lds
  s_add_u32 s21, s21, 1280
  s_add_u32 m0, s64, 33408
  s_nop 0
  buffer_load_dwordx4 v4, s[16:19], s21 offen nt lds
  s_add_u32 s21, s21, 1280
  s_add_u32 m0, s64, 34048
  s_nop 0
  buffer_load_dwordx4 v4, s[16:19], s21 offen nt lds
  s_add_u32 s21, s21, 1280
  s_add_u32 m0, s64, 34688
  s_nop 0
  buffer_load_dwordx4 v4, s[16:19], s21 offen nt lds
  s_add_u32 s21, s21, 1280
  s_add_u32 m0, s64, 35328
  s_nop 0
  buffer_load_dwordx4 v4, s[16:19], s21 offen nt lds
  s_add_u32 s21, s21, 1280
  s_add_u32 m0, s64, 35968
  s_nop 0
  buffer_load_dwordx4 v4, s[16:19], s21 offen nt lds
  s_add_u32 s21, s21, 1280
  s_add_u32 m0, s64, 36608
  s_nop 0
  buffer_load_dwordx4 v4, s[16:19], s21 offen nt lds
  s_add_u32 s21, s21, 1280
  s_add_u32 m0, s64, 37248
  s_nop 0
  buffer_load_dwordx4 v4, s[16:19], s21 offen nt lds
  s_mov_b64 exec, -1
  s_mov_b32 exec_hi, 65535
  s_add_u32 m0, s65, 57344
  s_nop 0
  buffer_load_dwordx4 v4, s[4:7], s20 offen nt lds
  s_add_u32 s20, s20, 3072
  s_add_u32 m0, s65, 58112
  s_nop 0
  buffer_load_dwordx4 v4, s[4:7], s20 offen nt lds
  s_add_u32 s20, s20, 3072
  s_add_u32 m0, s65, 58880
  s_nop 0
  buffer_load_dwordx4 v4, s[4:7], s20 offen nt lds
  s_add_u32 s20, s20, 3072
  s_add_u32 m0, s65, 59648
  s_nop 0
  buffer_load_dwordx4 v4, s[4:7], s20 offen nt lds
  s_add_u32 s20, s20, 3072
  s_add_u32 m0, s65, 60416
  s_nop 0
  buffer_load_dwordx4 v4, s[4:7], s20 offen nt lds
  s_add_u32 s20, s20, 3072
  s_add_u32 m0, s65, 61184
  s_nop 0
  buffer_load_dwordx4 v4, s[4:7], s20 offen nt lds
  s_add_u32 s20, s20, 3072
  s_add_u32 m0, s65, 61952
  s_nop 0
  buffer_load_dwordx4 v4, s[4:7], s20 offen nt lds
  s_add_u32 s20, s20, 3072
  s_add_u32 m0, s65, 62720
  s_nop 0
  buffer_load_dwordx4 v4, s[4:7], s20 offen nt lds
  s_mov_b64 exec, -1
  s_mov_b32 s16, s58
  s_mov_b32 s17, s59
  s_mov_b32 s18, 1966080
  s_mov_b32 s44, 37151232
  s_mov_b32 s38, s37
  s_mov_b32 exec_hi, 255
  s_add_u32 m0, s64, 83968
  s_nop 0
  buffer_load_dwordx4 v4, s[16:19], s66 offen nt lds
  s_add_u32 s66, s66, 1280
  s_add_u32 m0, s64, 84608
  s_nop 0
  buffer_load_dwordx4 v4, s[16:19], s66 offen nt lds
  s_add_u32 s66, s66, 1280
  s_add_u32 m0, s64, 85248
  s_nop 0
  buffer_load_dwordx4 v4, s[16:19], s66 offen nt lds
  s_add_u32 s66, s66, 1280
  s_add_u32 m0, s64, 85888
  s_nop 0
  buffer_load_dwordx4 v4, s[16:19], s66 offen nt lds
  s_add_u32 s66, s66, 1280
  s_add_u32 m0, s64, 86528
  s_nop 0
  buffer_load_dwordx4 v4, s[16:19], s66 offen nt lds
  s_add_u32 s66, s66, 1280
  s_add_u32 m0, s64, 87168
  s_nop 0
  buffer_load_dwordx4 v4, s[16:19], s66 offen nt lds
  s_add_u32 s66, s66, 1280
  s_add_u32 m0, s64, 87808
  s_nop 0
  buffer_load_dwordx4 v4, s[16:19], s66 offen nt lds
  s_add_u32 s66, s66, 1280
  s_add_u32 m0, s64, 88448
  s_nop 0
  buffer_load_dwordx4 v4, s[16:19], s66 offen nt lds
  s_mov_b64 exec, -1
  s_waitcnt vmcnt(16)
  s_barrier
  s_getreg_b32 s33, hwreg(HW_REG_XCC_ID, 0, 4)
  s_lshl_b32 s33, 1, s33
  v_mov_b32 v73, s33
  s_and_b32 s33, s45, 7
  s_lshl_b32 s33, s33, 7
  s_add_u32 s33, s33, 37044736
  s_and_b32 exec_lo, s62, 1
  s_mov_b32 exec_hi, 0
  buffer_atomic_or v73, v72, s[24:27], s33 offen sc1
  s_mov_b64 exec, -1
  ds_read_b32 v86, v75 offset:32768
  ds_read_b32 v87, v75 offset:33408
  ds_read_b32 v88, v75 offset:34048
  ds_read_b32 v89, v75 offset:34688
  ds_read_b32 v90, v75 offset:35328
  ds_read_b32 v91, v75 offset:35968
  ds_read_b32 v92, v75 offset:36608
  ds_read_b32 v93, v75 offset:37248
  ds_read_b32 v94, v75 offset:32832
  ds_read_b32 v95, v75 offset:33472
  ds_read_b32 v96, v75 offset:34112
  ds_read_b32 v97, v75 offset:34752
  ds_read_b32 v98, v75 offset:35392
  ds_read_b32 v99, v75 offset:36032
  ds_read_b32 v100, v75 offset:36672
  ds_read_b32 v101, v75 offset:37312
  ds_read_u16 v102, v76 offset:32768
  ds_read_u16 v103, v76 offset:33408
  ds_read_u16 v104, v76 offset:34048
  ds_read_u16 v105, v76 offset:34688
  ds_read_u16 v106, v76 offset:35328
  ds_read_u16 v107, v76 offset:35968
  ds_read_u16 v108, v76 offset:36608
  ds_read_u16 v109, v76 offset:37248
  s_waitcnt lgkmcnt(15)
  v_perm_b32 v184, v87, v86, s36
  v_perm_b32 v185, v89, v88, s36
  v_perm_b32 v186, v91, v90, s36
  v_perm_b32 v187, v93, v92, s36
  v_perm_b32 v188, v87, v86, s38
  v_perm_b32 v189, v89, v88, s38
  v_perm_b32 v190, v91, v90, s38
  v_perm_b32 v191, v93, v92, s38
  s_waitcnt lgkmcnt(11)
  v_perm_b32 v192, v95, v94, s36
  v_perm_b32 v193, v97, v96, s36
  s_waitcnt lgkmcnt(7)
  v_perm_b32 v194, v99, v98, s36
  v_perm_b32 v195, v101, v100, s36
  v_perm_b32 v196, v95, v94, s38
  v_perm_b32 v197, v97, v96, s38
  v_perm_b32 v198, v99, v98, s38
  v_perm_b32 v199, v101, v100, s38
  s_waitcnt lgkmcnt(6)
  v_lshl_or_b32 v200, v103, 16, v102
  s_waitcnt lgkmcnt(4)
  v_lshl_or_b32 v201, v105, 16, v104
  s_waitcnt lgkmcnt(2)
  v_lshl_or_b32 v202, v107, 16, v106
  s_waitcnt lgkmcnt(0)
  v_lshl_or_b32 v203, v109, 16, v108
  buffer_store_dwordx4 v[184:187], v4, s[24:27], s46 offen offset:0 sc1
  buffer_store_dwordx4 v[188:191], v4, s[24:27], s46 offen offset:1024 sc1
  buffer_store_dwordx4 v[192:195], v4, s[24:27], s46 offen offset:2048 sc1
  buffer_store_dwordx4 v[196:199], v4, s[24:27], s46 offen offset:3072 sc1
  s_add_u32 s46, s46, 4096
  buffer_store_dwordx4 v[200:203], v4, s[24:27], s46 offen offset:0 sc1
  v_add_u32 v75, 83968, v75
  v_add_u32 v76, 83968, v76
  s_waitcnt vmcnt(0)
  s_barrier
  s_mov_b64 exec, s[62:63]
  buffer_atomic_add v5, v6, s[24:27], s44 offen sc1
  s_mov_b64 exec, -1
  ds_read_b32 v110, v77 offset:0
  ds_read_b32 v111, v77 offset:768
  ds_read_b32 v112, v77 offset:1536
  ds_read_b32 v113, v77 offset:2304
  ds_read_b32 v114, v77 offset:3072
  ds_read_b32 v115, v77 offset:3840
  ds_read_b32 v116, v77 offset:4608
  ds_read_b32 v117, v77 offset:5376
  ds_read_b32 v118, v77 offset:64
  ds_read_b32 v119, v77 offset:832
  ds_read_b32 v120, v77 offset:1600
  ds_read_b32 v121, v77 offset:2368
  ds_read_b32 v122, v77 offset:3136
  ds_read_b32 v123, v77 offset:3904
  ds_read_b32 v124, v77 offset:4672
  ds_read_b32 v125, v77 offset:5440
  ds_read_b32 v126, v77 offset:128
  ds_read_b32 v127, v77 offset:896
  ds_read_b32 v128, v77 offset:1664
  ds_read_b32 v129, v77 offset:2432
  ds_read_b32 v130, v77 offset:3200
  ds_read_b32 v131, v77 offset:3968
  ds_read_b32 v132, v77 offset:4736
  ds_read_b32 v133, v77 offset:5504
  ds_read_b32 v86, v75 offset:0
  ds_read_b32 v87, v75 offset:640
  ds_read_b32 v88, v75 offset:1280
  ds_read_b32 v89, v75 offset:1920
  ds_read_b32 v90, v75 offset:2560
  ds_read_b32 v91, v75 offset:3200
  ds_read_b32 v92, v75 offset:3840
  ds_read_b32 v93, v75 offset:4480
  ds_read_b32 v94, v75 offset:64
  ds_read_b32 v95, v75 offset:704
  ds_read_b32 v96, v75 offset:1344
  ds_read_b32 v97, v75 offset:1984
  ds_read_b32 v98, v75 offset:2624
  ds_read_b32 v99, v75 offset:3264
  ds_read_b32 v100, v75 offset:3904
  ds_read_b32 v101, v75 offset:4544
  ds_read_u16 v102, v76 offset:0
  ds_read_u16 v103, v76 offset:640
  ds_read_u16 v104, v76 offset:1280
  ds_read_u16 v105, v76 offset:1920
  ds_read_u16 v106, v76 offset:2560
  ds_read_u16 v107, v76 offset:3200
  ds_read_u16 v108, v76 offset:3840
  ds_read_u16 v109, v76 offset:4480
  s_waitcnt lgkmcnt(15)
  v_perm_b32 v160, v111, v110, s36
  v_perm_b32 v161, v113, v112, s36
  v_perm_b32 v162, v115, v114, s36
  v_perm_b32 v163, v117, v116, s36
  v_perm_b32 v164, v111, v110, s38
  v_perm_b32 v165, v113, v112, s38
  v_perm_b32 v166, v115, v114, s38
  v_perm_b32 v167, v117, v116, s38
  v_perm_b32 v168, v119, v118, s36
  v_perm_b32 v169, v121, v120, s36
  v_perm_b32 v170, v123, v122, s36
  v_perm_b32 v171, v125, v124, s36
  v_perm_b32 v172, v119, v118, s38
  v_perm_b32 v173, v121, v120, s38
  v_perm_b32 v174, v123, v122, s38
  v_perm_b32 v175, v125, v124, s38
  v_perm_b32 v176, v127, v126, s36
  v_perm_b32 v177, v129, v128, s36
  v_perm_b32 v178, v131, v130, s36
  v_perm_b32 v179, v133, v132, s36
  v_perm_b32 v180, v127, v126, s38
  v_perm_b32 v181, v129, v128, s38
  v_perm_b32 v182, v131, v130, s38
  v_perm_b32 v183, v133, v132, s38
  buffer_store_dwordx4 v[160:163], v4, s[24:27], s8 offen offset:0 sc1
  buffer_store_dwordx4 v[164:167], v4, s[24:27], s8 offen offset:1024 sc1
  buffer_store_dwordx4 v[168:171], v4, s[24:27], s8 offen offset:2048 sc1
  buffer_store_dwordx4 v[172:175], v4, s[24:27], s8 offen offset:3072 sc1
  s_add_u32 s8, s8, s69
  buffer_store_dwordx4 v[176:179], v4, s[24:27], s8 offen offset:0 sc1
  buffer_store_dwordx4 v[180:183], v4, s[24:27], s8 offen offset:1024 sc1
  v_perm_b32 v136, v87, v86, s36
  v_perm_b32 v137, v89, v88, s36
  v_perm_b32 v138, v91, v90, s36
  v_perm_b32 v139, v93, v92, s36
  v_perm_b32 v140, v87, v86, s38
  v_perm_b32 v141, v89, v88, s38
  v_perm_b32 v142, v91, v90, s38
  v_perm_b32 v143, v93, v92, s38
  s_waitcnt lgkmcnt(11)
  v_perm_b32 v144, v95, v94, s36
  v_perm_b32 v145, v97, v96, s36
  s_waitcnt lgkmcnt(7)
  v_perm_b32 v146, v99, v98, s36
  v_perm_b32 v147, v101, v100, s36
  v_perm_b32 v148, v95, v94, s38
  v_perm_b32 v149, v97, v96, s38
  v_perm_b32 v150, v99, v98, s38
  v_perm_b32 v151, v101, v100, s38
  s_waitcnt lgkmcnt(6)
  v_lshl_or_b32 v152, v103, 16, v102
  s_waitcnt lgkmcnt(4)
  v_lshl_or_b32 v153, v105, 16, v104
  s_waitcnt lgkmcnt(2)
  v_lshl_or_b32 v154, v107, 16, v106
  s_waitcnt lgkmcnt(0)
  v_lshl_or_b32 v155, v109, 16, v108
  buffer_store_dwordx4 v[136:139], v4, s[24:27], s67 offen offset:0 sc1
  buffer_store_dwordx4 v[140:143], v4, s[24:27], s67 offen offset:1024 sc1
  buffer_store_dwordx4 v[144:147], v4, s[24:27], s67 offen offset:2048 sc1
  buffer_store_dwordx4 v[148:151], v4, s[24:27], s67 offen offset:3072 sc1
  s_add_u32 s67, s67, 4096
  buffer_store_dwordx4 v[152:155], v4, s[24:27], s67 offen offset:0 sc1
  v_mfma_f32_16x16x32_bf16 v[16:19], v[80:83], v[184:187], 0
  v_mfma_f32_16x16x32_bf16 v[20:23], v[80:83], v[188:191], 0
  v_mfma_f32_16x16x32_bf16 v[24:27], v[80:83], v[192:195], 0
  v_mfma_f32_16x16x32_bf16 v[28:31], v[80:83], v[196:199], 0
  v_mfma_f32_16x16x32_bf16 v[32:35], v[80:83], v[200:203], 0
  s_mov_b32 exec_lo, s10
  s_mov_b32 exec_hi, 0
  s_nop 1
  buffer_atomic_add_f32 v16, v78, s[24:27], s47 offen offset:0 sc1
  buffer_atomic_add_f32 v20, v78, s[24:27], s47 offen offset:64 sc1
  buffer_atomic_add_f32 v24, v78, s[24:27], s47 offen offset:128 sc1
  buffer_atomic_add_f32 v28, v78, s[24:27], s47 offen offset:192 sc1
  buffer_atomic_add_f32 v32, v78, s[24:27], s47 offen offset:256 sc1
  s_mov_b64 exec, -1
  v_mfma_f32_16x16x32_bf16 v[40:43], v[80:83], v[160:163], 0
  v_mfma_f32_16x16x32_bf16 v[44:47], v[80:83], v[164:167], 0
  v_mfma_f32_16x16x32_bf16 v[48:51], v[80:83], v[168:171], 0
  v_mfma_f32_16x16x32_bf16 v[52:55], v[80:83], v[172:175], 0
  v_mfma_f32_16x16x32_bf16 v[56:59], v[80:83], v[176:179], 0
  v_mfma_f32_16x16x32_bf16 v[60:63], v[80:83], v[180:183], 0
  s_mov_b32 exec_lo, s68
  s_mov_b32 exec_hi, 0
  s_nop 0
  buffer_atomic_add_f32 v40, v78, s[24:27], s9 offen offset:0 sc1
  buffer_atomic_add_f32 v44, v78, s[24:27], s9 offen offset:64 sc1
  buffer_atomic_add_f32 v48, v78, s[24:27], s9 offen offset:128 sc1
  buffer_atomic_add_f32 v52, v78, s[24:27], s9 offen offset:192 sc1
  buffer_atomic_add_f32 v56, v78, s[24:27], s9 offen offset:256 sc1
  buffer_atomic_add_f32 v60, v78, s[24:27], s9 offen offset:320 sc1
  s_mov_b64 exec, -1
  v_accvgpr_write_b32 a254, -1
  s_mov_b32 s33, 37151232
  s_mov_b64 exec, s[62:63]
  v_accvgpr_write_b32 a254, 0
  s_nop 1
  buffer_atomic_add a254, v7, s[24:27], s33 offen sc0 sc1
  s_mov_b64 exec, -1
  s_and_b32 s33, s45, 7
  s_lshl_b32 s33, s33, 3
  s_lshr_b32 s32, s45, 5
  s_add_u32 s33, s33, s32
  s_lshl_b32 s37, s33, 2
  s_add_u32 s37, s37, s3
  s_lshl_b32 s37, s37, 3
  s_bfe_u32 s32, s45, 0x10004
  s_add_u32 s32, s32, 1
  s_sub_u32 s33, 0, s32
  s_bitcmp1_b32 s45, 3
  s_cselect_b32 s32, s32, s33
  s_add_u32 s37, s37, s32
  s_bfe_u32 s33, s45, 0x20003
  s_lshl_b32 s33, s33, 1
  s_and_b32 s32, s3, 1
  s_add_u32 s33, s33, s32
  s_mul_i32 s39, s33, 102400
  s_lshr_b32 s32, s3, 1
  s_mul_i32 s32, s32, 51200
  s_add_u32 s39, s39, s32
  s_add_u32 s39, s39, 31457280
  s_movk_i32 s32, 2047
  v_lshrrev_b32 v9, 1, v2
  v_and_b32 v10, 1, v2
  v_lshlrev_b32 v10, 4, v10
  v_lshl_add_u32 v11, v1, 5, v10
  v_lshl_add_u32 v84, v9, 9, v11
  v_lshrrev_b32 v11, 3, v1
  v_lshl_add_u32 v11, v11, 2, v9
  v_add_u32 v11, s37, v11
  v_and_b32 v12, 7, v1
  v_lshl_add_u32 v12, v12, 5, v10
  v_add_u32 v9, 2, v11
  v_med3_i32 v11, v11, 0, s32
  v_med3_i32 v9, v9, 0, s32
  v_mul_u32_u24 v11, 1280, v11
  v_mul_u32_u24 v9, 1280, v9
  v_add_u32 v85, v11, v12
  v_add_u32 v12, v9, v12
  s_add_u32 s21, s37, 0
  s_max_i32 s21, s21, 0
  s_min_i32 s21, s21, s32
  s_mul_i32 s52, s21, 1280
  s_add_u32 s21, s37, 1
  s_max_i32 s21, s21, 0
  s_min_i32 s21, s21, s32
  s_mul_i32 s53, s21, 1280
  s_add_u32 s21, s37, 2
  s_max_i32 s21, s21, 0
  s_min_i32 s21, s21, s32
  s_mul_i32 s54, s21, 1280
  s_add_u32 s21, s37, 3
  s_max_i32 s21, s21, 0
  s_min_i32 s21, s21, s32
  s_mul_i32 s55, s21, 1280
  s_add_u32 s21, s37, 4
  s_max_i32 s21, s21, 0
  s_min_i32 s21, s21, s32
  s_mul_i32 s56, s21, 1280
  s_add_u32 s21, s37, 5
  s_max_i32 s21, s21, 0
  s_min_i32 s21, s21, s32
  s_mul_i32 s57, s21, 1280
  s_add_u32 s21, s37, 6
  s_max_i32 s21, s21, 0
  s_min_i32 s21, s21, s32
  s_mul_i32 s58, s21, 1280
  s_add_u32 s21, s37, 7
  s_max_i32 s21, s21, 0
  s_min_i32 s21, s21, s32
  s_mul_i32 s59, s21, 1280
  s_and_b32 s33, s45, 7
  s_lshl_b32 s33, s33, 9
  s_add_u32 s33, s33, 37040640
  v_min_u32 v10, 2, v2
  v_lshlrev_b32 v10, 14, v10
  v_max_u32 v10, 8192, v10
  v_and_b32 v9, 3, v1
  v_lshl_add_u32 v10, v9, 7, v10
  buffer_load_dword a255, v10, s[24:27], s33 offen sc1
  buffer_load_dwordx4 a[200:203], v84, s[12:15], s52 offen
  buffer_load_dwordx4 a[216:219], v84, s[12:15], s56 offen
  buffer_load_dwordx4 a[232:235], v85, s[12:15], 0 offen offset:1024
  buffer_load_dwordx4 a[204:207], v84, s[12:15], s53 offen
  buffer_load_dwordx4 a[220:223], v84, s[12:15], s57 offen
  buffer_load_dwordx4 a[208:211], v84, s[12:15], s54 offen
  buffer_load_dwordx4 a[224:227], v84, s[12:15], s58 offen
  buffer_load_dwordx4 a[236:239], v12, s[12:15], 0 offen offset:1024
  buffer_load_dwordx4 a[212:215], v84, s[12:15], s55 offen
  buffer_load_dwordx4 a[228:231], v84, s[12:15], s59 offen
  s_branch JOIN
FFT_COLS:
  v_lshl_add_u32 v9, v1, 1, 0
  v_cvt_f32_u32 v77, v9
  v_mul_f32 v77, 0x3d000000, v77
  v_mul_f32 v78, v77, v64
  v_fmamk_f32 v9, v77, 0x00000000, v78
  v_cos_f32 v11, v9
  v_sin_f32 v12, v9
  s_nop 0
  v_cvt_pk_bf16_f32 v80, v11, v12
  v_cvt_pk_bf16_f32 v96, -v12, v11
  v_fmamk_f32 v9, v77, 0x40000000, v78
  v_cos_f32 v11, v9
  v_sin_f32 v12, v9
  s_nop 0
  v_cvt_pk_bf16_f32 v81, v11, v12
  v_cvt_pk_bf16_f32 v97, -v12, v11
  v_fmamk_f32 v9, v77, 0x40800000, v78
  v_cos_f32 v11, v9
  v_sin_f32 v12, v9
  s_nop 0
  v_cvt_pk_bf16_f32 v82, v11, v12
  v_cvt_pk_bf16_f32 v98, -v12, v11
  v_fmamk_f32 v9, v77, 0x40c00000, v78
  v_cos_f32 v11, v9
  v_sin_f32 v12, v9
  s_nop 0
  v_cvt_pk_bf16_f32 v83, v11, v12
  v_cvt_pk_bf16_f32 v99, -v12, v11
  v_fmamk_f32 v9, v77, 0x3f800000, v78
  v_cos_f32 v11, v9
  v_sin_f32 v12, v9
  s_nop 0
  v_cvt_pk_bf16_f32 v84, v11, v12
  v_cvt_pk_bf16_f32 v100, -v12, v11
  v_fmamk_f32 v9, v77, 0x40400000, v78
  v_cos_f32 v11, v9
  v_sin_f32 v12, v9
  s_nop 0
  v_cvt_pk_bf16_f32 v85, v11, v12
  v_cvt_pk_bf16_f32 v101, -v12, v11
  v_fmamk_f32 v9, v77, 0x40a00000, v78
  v_cos_f32 v11, v9
  v_sin_f32 v12, v9
  s_nop 0
  v_cvt_pk_bf16_f32 v86, v11, v12
  v_cvt_pk_bf16_f32 v102, -v12, v11
  v_fmamk_f32 v9, v77, 0x40e00000, v78
  v_cos_f32 v11, v9
  v_sin_f32 v12, v9
  s_nop 0
  v_cvt_pk_bf16_f32 v87, v11, v12
  v_cvt_pk_bf16_f32 v103, -v12, v11
  v_cvt_f32_u32 v10, s69
  v_add_f32 v10, v10, v64
  v_mul_f32 v77, 0x3c800000, v77
  v_mul_f32 v78, v77, v10
  v_fmamk_f32 v9, v77, 0x00000000, v78
  v_cos_f32 v112, v9
  v_sin_f32 v120, v9
  v_fmamk_f32 v9, v77, 0x3f800000, v78
  v_cos_f32 v113, v9
  v_sin_f32 v121, v9
  v_fmamk_f32 v9, v77, 0x40000000, v78
  v_cos_f32 v114, v9
  v_sin_f32 v122, v9
  v_fmamk_f32 v9, v77, 0x40400000, v78
  v_cos_f32 v115, v9
  v_sin_f32 v123, v9
  s_nop 4
  s_cmp_lg_u32 s3, 0
  s_cbranch_scc1 POLL2_OUT
  s_mov_b64 exec, 0xffff
  s_movk_i32 s22, 0x7fff
POLL2:
  v_mov_b32 v12, 0
  buffer_atomic_add v12, v7, s[24:27], s23 offen sc0 sc1
  s_waitcnt vmcnt(0)
  v_cmp_gt_u32 vcc, 16, v12
  s_sub_u32 s22, s22, 1
  s_cbranch_scc1 POLL2_END
  s_cbranch_vccnz POLL2
POLL2_END:
  s_mov_b64 exec, -1
POLL2_OUT:
  s_nop 4
  s_barrier
  s_add_u32 m0, s38, 0
  s_nop 0
  buffer_load_dwordx4 v75, s[24:27], s30 offen sc1 lds
  s_add_u32 s30, s30, 40960
  s_add_u32 m0, s38, 1024
  s_nop 0
  buffer_load_dwordx4 v75, s[24:27], s30 offen sc1 lds
  s_add_u32 s30, s30, 20480
  s_add_u32 m0, s38, 2048
  s_nop 0
  buffer_load_dwordx4 v75, s[24:27], s30 offen sc1 lds
  s_add_u32 s30, s30, 40960
  s_add_u32 m0, s38, 3072
  s_nop 0
  buffer_load_dwordx4 v75, s[24:27], s30 offen sc1 lds
  s_add_u32 m0, s38, 16384
  s_nop 0
  buffer_load_dwordx4 v76, s[24:27], s34 offen sc1 lds
  s_add_u32 s34, s34, 40960
  s_add_u32 m0, s38, 17408
  s_nop 0
  buffer_load_dwordx4 v76, s[24:27], s34 offen sc1 lds
  s_add_u32 s34, s34, 20480
  s_add_u32 m0, s38, 18432
  s_nop 0
  buffer_load_dwordx4 v76, s[24:27], s34 offen sc1 lds
  s_add_u32 s34, s34, 40960
  s_add_u32 m0, s38, 19456
  s_nop 0
  buffer_load_dwordx4 v76, s[24:27], s34 offen sc1 lds
  s_mov_b32 s35, s38
  v_lshl_add_u32 v9, v1, 1, 1
  v_cvt_f32_u32 v77, v9
  v_mul_f32 v77, 0x3d000000, v77
  v_mul_f32 v78, v77, v64
  v_fmamk_f32 v9, v77, 0x00000000, v78
  v_cos_f32 v11, v9
  v_sin_f32 v12, v9
  s_nop 0
  v_cvt_pk_bf16_f32 v88, v11, v12
  v_cvt_pk_bf16_f32 v104, -v12, v11
  v_fmamk_f32 v9, v77, 0x40000000, v78
  v_cos_f32 v11, v9
  v_sin_f32 v12, v9
  s_nop 0
  v_cvt_pk_bf16_f32 v89, v11, v12
  v_cvt_pk_bf16_f32 v105, -v12, v11
  v_fmamk_f32 v9, v77, 0x40800000, v78
  v_cos_f32 v11, v9
  v_sin_f32 v12, v9
  s_nop 0
  v_cvt_pk_bf16_f32 v90, v11, v12
  v_cvt_pk_bf16_f32 v106, -v12, v11
  v_fmamk_f32 v9, v77, 0x40c00000, v78
  v_cos_f32 v11, v9
  v_sin_f32 v12, v9
  s_nop 0
  v_cvt_pk_bf16_f32 v91, v11, v12
  v_cvt_pk_bf16_f32 v107, -v12, v11
  v_fmamk_f32 v9, v77, 0x3f800000, v78
  v_cos_f32 v11, v9
  v_sin_f32 v12, v9
  s_nop 0
  v_cvt_pk_bf16_f32 v92, v11, v12
  v_cvt_pk_bf16_f32 v108, -v12, v11
  v_fmamk_f32 v9, v77, 0x40400000, v78
  v_cos_f32 v11, v9
  v_sin_f32 v12, v9
  s_nop 0
  v_cvt_pk_bf16_f32 v93, v11, v12
  v_cvt_pk_bf16_f32 v109, -v12, v11
  v_fmamk_f32 v9, v77, 0x40a00000, v78
  v_cos_f32 v11, v9
  v_sin_f32 v12, v9
  s_nop 0
  v_cvt_pk_bf16_f32 v94, v11, v12
  v_cvt_pk_bf16_f32 v110, -v12, v11
  v_fmamk_f32 v9, v77, 0x40e00000, v78
  v_cos_f32 v11, v9
  v_sin_f32 v12, v9
  s_nop 0
  v_cvt_pk_bf16_f32 v95, v11, v12
  v_cvt_pk_bf16_f32 v111, -v12, v11
  v_cvt_f32_u32 v10, s69
  v_add_f32 v10, v10, v64
  v_mul_f32 v77, 0x3c800000, v77
  v_mul_f32 v78, v77, v10
  v_fmamk_f32 v9, v77, 0x00000000, v78
  v_cos_f32 v116, v9
  v_sin_f32 v124, v9
  v_fmamk_f32 v9, v77, 0x3f800000, v78
  v_cos_f32 v117, v9
  v_sin_f32 v125, v9
  v_fmamk_f32 v9, v77, 0x40000000, v78
  v_cos_f32 v118, v9
  v_sin_f32 v126, v9
  v_fmamk_f32 v9, v77, 0x40400000, v78
  v_cos_f32 v119, v9
  v_sin_f32 v127, v9
  v_lshrrev_b32 v9, 2, v1
  v_xor_b32 v10, 0, v9
  v_lshlrev_b32 v10, 4, v10
  v_lshl_add_u32 v128, v3, 6, v10
  v_add_u32 v132, s35, v128
  v_xor_b32 v10, 1, v9
  v_lshlrev_b32 v10, 4, v10
  v_lshl_add_u32 v129, v3, 6, v10
  v_add_u32 v133, s35, v129
  v_xor_b32 v10, 2, v9
  v_lshlrev_b32 v10, 4, v10
  v_lshl_add_u32 v130, v3, 6, v10
  v_add_u32 v134, s35, v130
  v_xor_b32 v10, 3, v9
  v_lshlrev_b32 v10, 4, v10
  v_lshl_add_u32 v131, v3, 6, v10
  v_add_u32 v135, s35, v131
  s_lshl_b32 s36, s3, 11
  v_add_u32 v136, s36, v4
  s_mov_b32 s36, 327680
  s_mul_i32 s38, s28, 1639
  s_lshr_b32 s38, s38, 16
  s_mul_i32 s38, s38, 40
  s_sub_u32 s38, s28, s38
  s_and_b32 s38, s38, 15
  v_xor_b32 v9, s38, v1
  v_lshlrev_b32 v9, 4, v9
  v_mad_u32_u24 v137, v2, s36, v9
  s_mul_i32 s40, s69, 40960
  s_lshl_b32 s36, s28, 8
  s_add_u32 s40, s40, s36
  s_add_u32 s40, s40, 7864320
  s_add_u32 s41, s40, 40960
  s_add_u32 s42, s40, 81920
  s_add_u32 s43, s40, 122880
  s_and_b32 s33, s45, 7
  s_lshl_b32 s33, s33, 3
  s_lshr_b32 s32, s45, 5
  s_add_u32 s33, s33, s32
  s_lshl_b32 s37, s33, 2
  s_add_u32 s37, s37, s3
  s_lshl_b32 s37, s37, 3
  s_bfe_u32 s32, s45, 0x10004
  s_add_u32 s32, s32, 1
  s_sub_u32 s33, 0, s32
  s_bitcmp1_b32 s45, 3
  s_cselect_b32 s32, s32, s33
  s_add_u32 s37, s37, s32
  s_bfe_u32 s33, s45, 0x20003
  s_lshl_b32 s33, s33, 1
  s_and_b32 s32, s3, 1
  s_add_u32 s33, s33, s32
  s_mul_i32 s39, s33, 102400
  s_lshr_b32 s32, s3, 1
  s_mul_i32 s32, s32, 51200
  s_add_u32 s39, s39, s32
  s_add_u32 s39, s39, 31457280
  s_movk_i32 s32, 2047
  v_lshrrev_b32 v9, 1, v2
  v_and_b32 v10, 1, v2
  v_lshlrev_b32 v10, 4, v10
  v_lshl_add_u32 v11, v1, 5, v10
  v_lshl_add_u32 v77, v9, 9, v11
  v_lshrrev_b32 v11, 3, v1
  v_lshl_add_u32 v11, v11, 2, v9
  v_add_u32 v11, s37, v11
  v_and_b32 v12, 7, v1
  v_lshl_add_u32 v12, v12, 5, v10
  v_add_u32 v9, 2, v11
  v_med3_i32 v11, v11, 0, s32
  v_med3_i32 v9, v9, 0, s32
  v_mul_u32_u24 v11, 1280, v11
  v_mul_u32_u24 v9, 1280, v9
  v_add_u32 v78, v11, v12
  v_add_u32 v79, v9, v12
  s_add_u32 s21, s37, 0
  s_max_i32 s21, s21, 0
  s_min_i32 s21, s21, s32
  s_mul_i32 s52, s21, 1280
  s_add_u32 s21, s37, 1
  s_max_i32 s21, s21, 0
  s_min_i32 s21, s21, s32
  s_mul_i32 s53, s21, 1280
  s_add_u32 s21, s37, 2
  s_max_i32 s21, s21, 0
  s_min_i32 s21, s21, s32
  s_mul_i32 s54, s21, 1280
  s_add_u32 s21, s37, 3
  s_max_i32 s21, s21, 0
  s_min_i32 s21, s21, s32
  s_mul_i32 s55, s21, 1280
  s_add_u32 s21, s37, 4
  s_max_i32 s21, s21, 0
  s_min_i32 s21, s21, s32
  s_mul_i32 s56, s21, 1280
  s_add_u32 s21, s37, 5
  s_max_i32 s21, s21, 0
  s_min_i32 s21, s21, s32
  s_mul_i32 s57, s21, 1280
  s_add_u32 s21, s37, 6
  s_max_i32 s21, s21, 0
  s_min_i32 s21, s21, s32
  s_mul_i32 s58, s21, 1280
  s_add_u32 s21, s37, 7
  s_max_i32 s21, s21, 0
  s_min_i32 s21, s21, s32
  s_mul_i32 s59, s21, 1280
  s_and_b32 s33, s45, 7
  s_lshl_b32 s33, s33, 9
  s_add_u32 s33, s33, 37040640
  v_min_u32 v10, 2, v2
  v_lshlrev_b32 v10, 14, v10
  v_max_u32 v10, 8192, v10
  v_and_b32 v9, 3, v1
  v_lshl_add_u32 v10, v9, 7, v10
  buffer_load_dword a255, v10, s[24:27], s33 offen sc1
  s_waitcnt vmcnt(5)
  s_barrier
  buffer_load_dwordx4 a[200:203], v77, s[12:15], s52 offen
  ds_read_b128 v[140:143], v128 offset:0
  ds_read_b128 v[196:199], v130 offset:0
  ds_read_b128 v[156:159], v128 offset:8192
  ds_read_b128 v[212:215], v130 offset:8192
  ds_read_b128 v[144:147], v129 offset:0
  ds_read_b128 v[200:203], v131 offset:0
  ds_read_b128 v[160:163], v129 offset:8192
  ds_read_b128 v[216:219], v131 offset:8192
  ds_read_b128 v[148:151], v128 offset:4096
  ds_read_b128 v[204:207], v130 offset:4096
  ds_read_b128 v[164:167], v128 offset:12288
  ds_read_b128 v[220:223], v130 offset:12288
  ds_read_b128 v[152:155], v129 offset:4096
  ds_read_b128 v[208:211], v131 offset:4096
  ds_read_b128 v[168:171], v129 offset:12288
  buffer_load_dwordx4 a[216:219], v77, s[12:15], s56 offen
  ds_read_b128 v[224:227], v131 offset:12288
  buffer_load_dwordx4 a[232:235], v78, s[12:15], 0 offen offset:1024
  s_waitcnt lgkmcnt(12)
  v_mfma_f32_16x16x32_bf16 v[172:175], v[140:143], v[16:19], 0
  v_mfma_f32_16x16x32_bf16 v[180:183], v[140:143], v[32:35], 0
  v_mfma_f32_16x16x32_bf16 v[228:231], v[196:199], v[16:19], 0
  v_mfma_f32_16x16x32_bf16 v[236:239], v[196:199], v[32:35], 0
  buffer_load_dwordx4 a[204:207], v77, s[12:15], s53 offen
  v_mfma_f32_16x16x32_bf16 v[176:179], v[156:159], v[16:19], 0
  v_mfma_f32_16x16x32_bf16 v[184:187], v[156:159], v[32:35], 0
  v_mfma_f32_16x16x32_bf16 v[232:235], v[212:215], v[16:19], 0
  v_mfma_f32_16x16x32_bf16 v[240:243], v[212:215], v[32:35], 0
  buffer_load_dwordx4 a[220:223], v77, s[12:15], s57 offen
  s_waitcnt lgkmcnt(8)
  v_mfma_f32_16x16x32_bf16 v[172:175], v[144:147], v[20:23], v[172:175]
  v_mfma_f32_16x16x32_bf16 v[180:183], v[144:147], v[36:39], v[180:183]
  v_mfma_f32_16x16x32_bf16 v[228:231], v[200:203], v[20:23], v[228:231]
  v_mfma_f32_16x16x32_bf16 v[236:239], v[200:203], v[36:39], v[236:239]
  buffer_load_dwordx4 a[208:211], v77, s[12:15], s54 offen
  v_mfma_f32_16x16x32_bf16 v[176:179], v[160:163], v[20:23], v[176:179]
  v_mfma_f32_16x16x32_bf16 v[184:187], v[160:163], v[36:39], v[184:187]
  v_mfma_f32_16x16x32_bf16 v[232:235], v[216:219], v[20:23], v[232:235]
  v_mfma_f32_16x16x32_bf16 v[240:243], v[216:219], v[36:39], v[240:243]
  buffer_load_dwordx4 a[224:227], v77, s[12:15], s58 offen
  s_waitcnt lgkmcnt(7)
  v_mfma_f32_16x16x32_bf16 v[172:175], v[148:151], v[24:27], v[172:175]
  v_mfma_f32_16x16x32_bf16 v[180:183], v[148:151], v[40:43], v[180:183]
  s_waitcnt lgkmcnt(6)
  v_mfma_f32_16x16x32_bf16 v[228:231], v[204:207], v[24:27], v[228:231]
  v_mfma_f32_16x16x32_bf16 v[236:239], v[204:207], v[40:43], v[236:239]
  buffer_load_dwordx4 a[236:239], v79, s[12:15], 0 offen offset:1024
  s_waitcnt lgkmcnt(5)
  v_mfma_f32_16x16x32_bf16 v[176:179], v[164:167], v[24:27], v[176:179]
  v_mfma_f32_16x16x32_bf16 v[184:187], v[164:167], v[40:43], v[184:187]
  s_waitcnt lgkmcnt(4)
  v_mfma_f32_16x16x32_bf16 v[232:235], v[220:223], v[24:27], v[232:235]
  v_mfma_f32_16x16x32_bf16 v[240:243], v[220:223], v[40:43], v[240:243]
  buffer_load_dwordx4 a[212:215], v77, s[12:15], s55 offen
  s_waitcnt lgkmcnt(3)
  v_mfma_f32_16x16x32_bf16 v[172:175], v[152:155], v[28:31], v[172:175]
  v_mfma_f32_16x16x32_bf16 v[180:183], v[152:155], v[44:47], v[180:183]
  s_waitcnt lgkmcnt(2)
  v_mfma_f32_16x16x32_bf16 v[228:231], v[208:211], v[28:31], v[228:231]
  s_nop 4
  v_mul_f32 v164, v172, v48
  v_mul_f32 v165, v173, v49
  v_mfma_f32_16x16x32_bf16 v[236:239], v[208:211], v[44:47], v[236:239]
  buffer_load_dwordx4 a[228:231], v77, s[12:15], s59 offen
  v_mul_f32 v166, v174, v50
  s_waitcnt lgkmcnt(1)
  v_mfma_f32_16x16x32_bf16 v[176:179], v[168:171], v[28:31], v[176:179]
  v_mul_f32 v167, v175, v51
  v_mul_f32 v220, v228, v48
  v_mfma_f32_16x16x32_bf16 v[184:187], v[168:171], v[44:47], v[184:187]
  v_mul_f32 v168, v180, v48
  v_mul_f32 v169, v181, v49
  s_waitcnt lgkmcnt(0)
  v_mfma_f32_16x16x32_bf16 v[232:235], v[224:227], v[28:31], v[232:235]
  v_mul_f32 v170, v182, v50
  v_mul_f32 v171, v183, v51
  v_mfma_f32_16x16x32_bf16 v[240:243], v[224:227], v[44:47], v[240:243]
  v_mul_f32 v224, v236, v48
  v_mul_f32 v221, v229, v49
  v_mul_f32 v225, v237, v49
  v_mul_f32 v222, v230, v50
  v_mul_f32 v226, v238, v50
  v_mul_f32 v223, v231, v51
  v_mul_f32 v227, v239, v51
  v_fmac_f32 v164, v180, v56
  v_fma_f32 v168, -v172, v56, v168
  v_fmac_f32 v165, v181, v57
  v_fma_f32 v169, -v173, v57, v169
  v_fmac_f32 v166, v182, v58
  v_fma_f32 v170, -v174, v58, v170
  v_fmac_f32 v167, v183, v59
  v_fma_f32 v171, -v175, v59, v171
  v_fmac_f32 v220, v236, v56
  v_fma_f32 v224, -v228, v56, v224
  v_fmac_f32 v221, v237, v57
  v_fma_f32 v225, -v229, v57, v225
  v_fmac_f32 v222, v238, v58
  v_fma_f32 v226, -v230, v58, v226
  v_fmac_f32 v223, v239, v59
  v_fma_f32 v227, -v231, v59, v227
  v_cvt_pk_bf16_f32 v188, v164, v168
  v_cvt_pk_bf16_f32 v189, v165, v169
  v_cvt_pk_bf16_f32 v190, v166, v170
  v_cvt_pk_bf16_f32 v191, v167, v171
  v_cvt_pk_bf16_f32 v244, v220, v224
  v_cvt_pk_bf16_f32 v245, v221, v225
  v_cvt_pk_bf16_f32 v246, v222, v226
  v_cvt_pk_bf16_f32 v247, v223, v227
  v_mul_f32 v164, v176, v52
  v_mul_f32 v168, v184, v52
  v_mul_f32 v165, v177, v53
  v_mul_f32 v169, v185, v53
  v_mul_f32 v166, v178, v54
  v_mul_f32 v170, v186, v54
  v_mul_f32 v167, v179, v55
  v_mul_f32 v171, v187, v55
  v_mul_f32 v220, v232, v52
  v_mul_f32 v224, v240, v52
  v_mul_f32 v221, v233, v53
  v_mul_f32 v225, v241, v53
  v_mul_f32 v222, v234, v54
  v_mul_f32 v226, v242, v54
  v_mul_f32 v223, v235, v55
  v_mul_f32 v227, v243, v55
  v_fmac_f32 v164, v184, v60
  v_fma_f32 v168, -v176, v60, v168
  v_fmac_f32 v165, v185, v61
  v_fma_f32 v169, -v177, v61, v169
  v_fmac_f32 v166, v186, v62
  v_fma_f32 v170, -v178, v62, v170
  v_fmac_f32 v167, v187, v63
  v_fma_f32 v171, -v179, v63, v171
  v_fmac_f32 v220, v240, v60
  v_fma_f32 v224, -v232, v60, v224
  v_fmac_f32 v221, v241, v61
  v_fma_f32 v225, -v233, v61, v225
  v_fmac_f32 v222, v242, v62
  v_fma_f32 v226, -v234, v62, v226
  v_fmac_f32 v223, v243, v63
  v_fma_f32 v227, -v235, v63, v227
  v_mfma_f32_16x16x32_bf16 v[172:175], v[80:83], v[188:191], 0
  v_cvt_pk_bf16_f32 v192, v164, v168
  v_cvt_pk_bf16_f32 v193, v165, v169
  v_mfma_f32_16x16x32_bf16 v[180:183], v[96:99], v[188:191], 0
  v_cvt_pk_bf16_f32 v194, v166, v170
  v_cvt_pk_bf16_f32 v195, v167, v171
  v_mfma_f32_16x16x32_bf16 v[176:179], v[88:91], v[188:191], 0
  v_cvt_pk_bf16_f32 v248, v220, v224
  v_cvt_pk_bf16_f32 v249, v221, v225
  v_mfma_f32_16x16x32_bf16 v[184:187], v[104:107], v[188:191], 0
  v_cvt_pk_bf16_f32 v250, v222, v226
  v_cvt_pk_bf16_f32 v251, v223, v227
  v_mfma_f32_16x16x32_bf16 v[228:231], v[80:83], v[244:247], 0
  v_mfma_f32_16x16x32_bf16 v[236:239], v[96:99], v[244:247], 0
  v_mfma_f32_16x16x32_bf16 v[232:235], v[88:91], v[244:247], 0
  v_mfma_f32_16x16x32_bf16 v[240:243], v[104:107], v[244:247], 0
  v_mfma_f32_16x16x32_bf16 v[172:175], v[84:87], v[192:195], v[172:175]
  v_mfma_f32_16x16x32_bf16 v[180:183], v[100:103], v[192:195], v[180:183]
  v_mfma_f32_16x16x32_bf16 v[176:179], v[92:95], v[192:195], v[176:179]
  v_mfma_f32_16x16x32_bf16 v[184:187], v[108:111], v[192:195], v[184:187]
  v_mfma_f32_16x16x32_bf16 v[228:231], v[84:87], v[248:251], v[228:231]
  v_mfma_f32_16x16x32_bf16 v[236:239], v[100:103], v[248:251], v[236:239]
  v_mfma_f32_16x16x32_bf16 v[232:235], v[92:95], v[248:251], v[232:235]
  v_mfma_f32_16x16x32_bf16 v[240:243], v[108:111], v[248:251], v[240:243]
  s_waitcnt vmcnt(11)
  s_bfe_u32 s33, s2, 0x20003
  s_cmp_eq_u32 s33, s3
  s_cselect_b64 exec, -1, 0
  s_getpc_b64 s[60:61]
PF2:
  s_add_u32 s60, s60, JOIN-PF2
  s_addc_u32 s61, s61, 0
  v_lshlrev_b32 v254, 7, v0
  v_min_u32 v254, KM_END-JOIN, v254
  global_load_dword a253, v254, s[60:61]
  s_mov_b64 exec, -1
  s_getreg_b32 s33, hwreg(HW_REG_XCC_ID, 0, 4)
  s_lshl_b32 s33, 1, s33
  v_mov_b32 v73, s33
  s_and_b32 s33, s45, 7
  s_lshl_b32 s33, s33, 7
  s_add_u32 s33, s33, 37044736
  s_and_b32 exec_lo, s62, 1
  s_mov_b32 exec_hi, 0
  buffer_atomic_or v73, v72, s[24:27], s33 offen sc1
  s_mov_b64 exec, -1
  ds_read_b128 v[156:159], v132 offset:16384
  ds_read_b128 v[160:163], v133 offset:16384
  ds_read_b128 v[212:215], v134 offset:16384
  ds_read_b128 v[216:219], v135 offset:16384
  s_waitcnt lgkmcnt(3)
  v_lshlrev_b32 v140, 16, v156
  v_lshlrev_b32 v141, 16, v158
  s_waitcnt lgkmcnt(2)
  v_lshlrev_b32 v142, 16, v160
  v_lshlrev_b32 v143, 16, v162
  v_and_b32 v148, 0xffff0000, v156
  v_and_b32 v149, 0xffff0000, v158
  v_and_b32 v150, 0xffff0000, v160
  v_and_b32 v151, 0xffff0000, v162
  v_mul_f32 v164, v172, v140
  v_mul_f32 v168, v180, v140
  v_mul_f32 v165, v173, v141
  v_mul_f32 v169, v181, v141
  v_mul_f32 v166, v174, v142
  v_mul_f32 v170, v182, v142
  v_mul_f32 v167, v175, v143
  v_mul_f32 v171, v183, v143
  s_waitcnt lgkmcnt(1)
  v_lshlrev_b32 v196, 16, v212
  v_lshlrev_b32 v197, 16, v214
  s_waitcnt lgkmcnt(0)
  v_lshlrev_b32 v198, 16, v216
  v_lshlrev_b32 v199, 16, v218
  v_fma_f32 v164, -v180, v148, v164
  v_fmac_f32 v168, v172, v148
  v_fma_f32 v165, -v181, v149, v165
  v_fmac_f32 v169, v173, v149
  v_fma_f32 v166, -v182, v150, v166
  v_fmac_f32 v170, v174, v150
  v_fma_f32 v167, -v183, v151, v167
  v_fmac_f32 v171, v175, v151
  v_and_b32 v204, 0xffff0000, v212
  v_and_b32 v205, 0xffff0000, v214
  v_and_b32 v206, 0xffff0000, v216
  v_and_b32 v207, 0xffff0000, v218
  v_mul_f32 v220, v228, v196
  v_mul_f32 v224, v236, v196
  v_mul_f32 v221, v229, v197
  v_mul_f32 v225, v237, v197
  v_mul_f32 v222, v230, v198
  v_mul_f32 v226, v238, v198
  v_mul_f32 v223, v231, v199
  v_mul_f32 v227, v239, v199
  v_cvt_pk_bf16_f32 v188, v168, v164
  v_cvt_pk_bf16_f32 v189, v169, v165
  v_cvt_pk_bf16_f32 v190, v170, v166
  v_cvt_pk_bf16_f32 v191, v171, v167
  v_lshlrev_b32 v144, 16, v157
  v_lshlrev_b32 v145, 16, v159
  v_lshlrev_b32 v146, 16, v161
  v_lshlrev_b32 v147, 16, v163
  v_fma_f32 v220, -v236, v204, v220
  v_fmac_f32 v224, v228, v204
  v_fma_f32 v221, -v237, v205, v221
  v_fmac_f32 v225, v229, v205
  v_fma_f32 v222, -v238, v206, v222
  v_fmac_f32 v226, v230, v206
  v_fma_f32 v223, -v239, v207, v223
  v_fmac_f32 v227, v231, v207
  v_and_b32 v152, 0xffff0000, v157
  v_and_b32 v153, 0xffff0000, v159
  v_and_b32 v154, 0xffff0000, v161
  v_and_b32 v155, 0xffff0000, v163
  v_mul_f32 v164, v176, v144
  v_mul_f32 v168, v184, v144
  v_mul_f32 v165, v177, v145
  v_mul_f32 v169, v185, v145
  v_mul_f32 v166, v178, v146
  v_mul_f32 v170, v186, v146
  v_mul_f32 v167, v179, v147
  v_mul_f32 v171, v187, v147
  v_cvt_pk_bf16_f32 v244, v224, v220
  v_cvt_pk_bf16_f32 v245, v225, v221
  v_cvt_pk_bf16_f32 v246, v226, v222
  v_cvt_pk_bf16_f32 v247, v227, v223
  v_lshlrev_b32 v200, 16, v213
  v_lshlrev_b32 v201, 16, v215
  v_lshlrev_b32 v202, 16, v217
  v_lshlrev_b32 v203, 16, v219
  v_fma_f32 v164, -v184, v152, v164
  v_fmac_f32 v168, v176, v152
  v_fma_f32 v165, -v185, v153, v165
  v_fmac_f32 v169, v177, v153
  v_fma_f32 v166, -v186, v154, v166
  v_fmac_f32 v170, v178, v154
  v_fma_f32 v167, -v187, v155, v167
  v_fmac_f32 v171, v179, v155
  v_mfma_f32_16x16x32_bf16 v[172:175], v[188:191], v[96:99], 0
  v_and_b32 v208, 0xffff0000, v213
  v_and_b32 v209, 0xffff0000, v215
  v_mfma_f32_16x16x32_bf16 v[180:183], v[188:191], v[80:83], 0
  v_and_b32 v210, 0xffff0000, v217
  v_and_b32 v211, 0xffff0000, v219
  v_mul_f32 v220, v232, v200
  v_mul_f32 v224, v240, v200
  v_mul_f32 v221, v233, v201
  v_mul_f32 v225, v241, v201
  v_mul_f32 v222, v234, v202
  v_mul_f32 v226, v242, v202
  v_mul_f32 v223, v235, v203
  v_mul_f32 v227, v243, v203
  v_cvt_pk_bf16_f32 v192, v168, v164
  v_cvt_pk_bf16_f32 v193, v169, v165
  v_cvt_pk_bf16_f32 v194, v170, v166
  v_cvt_pk_bf16_f32 v195, v171, v167
  v_fma_f32 v220, -v240, v208, v220
  v_fmac_f32 v224, v232, v208
  v_fma_f32 v221, -v241, v209, v221
  v_fmac_f32 v225, v233, v209
  v_fma_f32 v222, -v242, v210, v222
  v_fmac_f32 v226, v234, v210
  v_fma_f32 v223, -v243, v211, v223
  v_fmac_f32 v227, v235, v211
  v_mfma_f32_16x16x32_bf16 v[228:231], v[244:247], v[96:99], 0
  v_cvt_pk_bf16_f32 v248, v224, v220
  v_cvt_pk_bf16_f32 v249, v225, v221
  v_mfma_f32_16x16x32_bf16 v[236:239], v[244:247], v[80:83], 0
  v_cvt_pk_bf16_f32 v250, v226, v222
  v_cvt_pk_bf16_f32 v251, v227, v223
  v_mfma_f32_16x16x32_bf16 v[176:179], v[188:191], v[104:107], 0
  v_mfma_f32_16x16x32_bf16 v[184:187], v[188:191], v[88:91], 0
  v_mfma_f32_16x16x32_bf16 v[172:175], v[192:195], v[100:103], v[172:175]
  v_mfma_f32_16x16x32_bf16 v[180:183], v[192:195], v[84:87], v[180:183]
  v_mfma_f32_16x16x32_bf16 v[232:235], v[244:247], v[104:107], 0
  s_nop 5
  v_mul_f32 v164, v172, v112
  v_mul_f32 v165, v173, v113
  v_mfma_f32_16x16x32_bf16 v[240:243], v[244:247], v[88:91], 0
  v_mul_f32 v168, v180, v112
  v_mul_f32 v169, v181, v113
  v_mfma_f32_16x16x32_bf16 v[228:231], v[248:251], v[100:103], v[228:231]
  v_mul_f32 v166, v174, v114
  v_mul_f32 v170, v182, v114
  v_mfma_f32_16x16x32_bf16 v[236:239], v[248:251], v[84:87], v[236:239]
  v_mul_f32 v167, v175, v115
  v_mul_f32 v171, v183, v115
  v_mfma_f32_16x16x32_bf16 v[176:179], v[192:195], v[108:111], v[176:179]
  v_fma_f32 v164, -v180, v120, v164
  v_fmac_f32 v168, v172, v120
  v_mfma_f32_16x16x32_bf16 v[184:187], v[192:195], v[92:95], v[184:187]
  v_fma_f32 v165, -v181, v121, v165
  v_fmac_f32 v169, v173, v121
  v_mfma_f32_16x16x32_bf16 v[232:235], v[248:251], v[108:111], v[232:235]
  v_fma_f32 v166, -v182, v122, v166
  v_fmac_f32 v170, v174, v122
  v_mfma_f32_16x16x32_bf16 v[240:243], v[248:251], v[92:95], v[240:243]
  v_fma_f32 v167, -v183, v123, v167
  v_fmac_f32 v171, v175, v123
  v_mul_f32 v220, v228, v112
  v_mul_f32 v224, v236, v112
  v_mul_f32 v221, v229, v113
  v_mul_f32 v225, v237, v113
  v_mul_f32 v222, v230, v114
  v_mul_f32 v226, v238, v114
  v_mul_f32 v223, v231, v115
  v_mul_f32 v227, v239, v115
  v_cvt_pk_bf16_f32 v188, v168, v164
  v_cvt_pk_bf16_f32 v189, v169, v165
  v_cvt_pk_bf16_f32 v190, v170, v166
  v_cvt_pk_bf16_f32 v191, v171, v167
  v_fma_f32 v220, -v236, v120, v220
  v_fmac_f32 v224, v228, v120
  v_fma_f32 v221, -v237, v121, v221
  v_fmac_f32 v225, v229, v121
  v_fma_f32 v222, -v238, v122, v222
  v_fmac_f32 v226, v230, v122
  v_fma_f32 v223, -v239, v123, v223
  v_fmac_f32 v227, v231, v123
  v_mul_f32 v164, v176, v116
  v_mul_f32 v168, v184, v116
  v_mul_f32 v165, v177, v117
  v_mul_f32 v169, v185, v117
  v_mul_f32 v166, v178, v118
  v_mul_f32 v170, v186, v118
  v_mul_f32 v167, v179, v119
  v_mul_f32 v171, v187, v119
  v_cvt_pk_bf16_f32 v244, v224, v220
  v_cvt_pk_bf16_f32 v245, v225, v221
  v_cvt_pk_bf16_f32 v246, v226, v222
  v_cvt_pk_bf16_f32 v247, v227, v223
  v_fma_f32 v164, -v184, v124, v164
  v_fmac_f32 v168, v176, v124
  v_fma_f32 v165, -v185, v125, v165
  v_fmac_f32 v169, v177, v125
  v_fma_f32 v166, -v186, v126, v166
  v_fmac_f32 v170, v178, v126
  v_fma_f32 v167, -v187, v127, v167
  v_fmac_f32 v171, v179, v127
  v_mul_f32 v220, v232, v116
  v_mul_f32 v224, v240, v116
  v_mul_f32 v221, v233, v117
  v_mul_f32 v225, v241, v117
  v_mul_f32 v222, v234, v118
  v_mul_f32 v226, v242, v118
  v_mul_f32 v223, v235, v119
  v_mul_f32 v227, v243, v119
  v_cvt_pk_bf16_f32 v192, v168, v164
  v_cvt_pk_bf16_f32 v193, v169, v165
  v_cvt_pk_bf16_f32 v194, v170, v166
  v_cvt_pk_bf16_f32 v195, v171, v167
  ds_write_b128 v136, v[188:191] offset:32768
  v_fma_f32 v220, -v240, v124, v220
  v_fmac_f32 v224, v232, v124
  v_fma_f32 v221, -v241, v125, v221
  v_fmac_f32 v225, v233, v125
  v_fma_f32 v222, -v242, v126, v222
  v_fmac_f32 v226, v234, v126
  v_fma_f32 v223, -v243, v127, v223
  v_fmac_f32 v227, v235, v127
  v_cvt_pk_bf16_f32 v248, v224, v220
  v_cvt_pk_bf16_f32 v249, v225, v221
  v_cvt_pk_bf16_f32 v250, v226, v222
  ds_write_b128 v136, v[192:195] offset:33792
  v_cvt_pk_bf16_f32 v251, v227, v223
  ds_write_b128 v136, v[244:247] offset:40960
  ds_write_b128 v136, v[248:251] offset:41984
  s_waitcnt lgkmcnt(0)
  s_barrier
  v_accvgpr_write_b32 a254, -1
  s_mov_b32 s33, 37151232
  s_mov_b64 exec, s[62:63]
  v_accvgpr_write_b32 a254, 0
  s_nop 1
  buffer_atomic_add a254, v7, s[24:27], s33 offen sc0 sc1
  s_mov_b64 exec, -1
  ds_read_b128 v[140:143], v4 offset:32768
  ds_read_b128 v[144:147], v4 offset:33792
  ds_read_b128 v[196:199], v4 offset:40960
  ds_read_b128 v[200:203], v4 offset:41984
  ds_read_b128 v[148:151], v4 offset:34816
  ds_read_b128 v[152:155], v4 offset:35840
  ds_read_b128 v[204:207], v4 offset:43008
  ds_read_b128 v[208:211], v4 offset:44032
  ds_read_b128 v[156:159], v4 offset:36864
  ds_read_b128 v[160:163], v4 offset:37888
  ds_read_b128 v[212:215], v4 offset:45056
  ds_read_b128 v[216:219], v4 offset:46080
  ds_read_b128 v[164:167], v4 offset:38912
  ds_read_b128 v[168:171], v4 offset:39936
  ds_read_b128 v[220:223], v4 offset:47104
  ds_read_b128 v[224:227], v4 offset:48128
  s_waitcnt lgkmcnt(12)
  v_mfma_f32_16x16x32_bf16 v[172:175], v[32:35], v[140:143], 0
  v_mfma_f32_16x16x32_bf16 v[180:183], v[16:19], v[140:143], 0
  v_mfma_f32_16x16x32_bf16 v[176:179], v[32:35], v[144:147], 0
  v_mfma_f32_16x16x32_bf16 v[184:187], v[16:19], v[144:147], 0
  v_mfma_f32_16x16x32_bf16 v[228:231], v[32:35], v[196:199], 0
  v_mfma_f32_16x16x32_bf16 v[236:239], v[16:19], v[196:199], 0
  v_mfma_f32_16x16x32_bf16 v[232:235], v[32:35], v[200:203], 0
  v_mfma_f32_16x16x32_bf16 v[240:243], v[16:19], v[200:203], 0
  s_waitcnt lgkmcnt(8)
  v_mfma_f32_16x16x32_bf16 v[172:175], v[36:39], v[148:151], v[172:175]
  v_mfma_f32_16x16x32_bf16 v[180:183], v[20:23], v[148:151], v[180:183]
  v_mfma_f32_16x16x32_bf16 v[176:179], v[36:39], v[152:155], v[176:179]
  v_mfma_f32_16x16x32_bf16 v[184:187], v[20:23], v[152:155], v[184:187]
  v_mfma_f32_16x16x32_bf16 v[228:231], v[36:39], v[204:207], v[228:231]
  v_mfma_f32_16x16x32_bf16 v[236:239], v[20:23], v[204:207], v[236:239]
  v_mfma_f32_16x16x32_bf16 v[232:235], v[36:39], v[208:211], v[232:235]
  v_mfma_f32_16x16x32_bf16 v[240:243], v[20:23], v[208:211], v[240:243]
  s_waitcnt lgkmcnt(7)
  v_mfma_f32_16x16x32_bf16 v[172:175], v[40:43], v[156:159], v[172:175]
  v_mfma_f32_16x16x32_bf16 v[180:183], v[24:27], v[156:159], v[180:183]
  s_waitcnt lgkmcnt(6)
  v_mfma_f32_16x16x32_bf16 v[176:179], v[40:43], v[160:163], v[176:179]
  v_mfma_f32_16x16x32_bf16 v[184:187], v[24:27], v[160:163], v[184:187]
  s_waitcnt lgkmcnt(5)
  v_mfma_f32_16x16x32_bf16 v[228:231], v[40:43], v[212:215], v[228:231]
  v_mfma_f32_16x16x32_bf16 v[236:239], v[24:27], v[212:215], v[236:239]
  s_waitcnt lgkmcnt(4)
  v_mfma_f32_16x16x32_bf16 v[232:235], v[40:43], v[216:219], v[232:235]
  v_mfma_f32_16x16x32_bf16 v[240:243], v[24:27], v[216:219], v[240:243]
  s_waitcnt lgkmcnt(3)
  v_mfma_f32_16x16x32_bf16 v[172:175], v[44:47], v[164:167], v[172:175]
  v_mfma_f32_16x16x32_bf16 v[180:183], v[28:31], v[164:167], v[180:183]
  s_waitcnt lgkmcnt(2)
  v_mfma_f32_16x16x32_bf16 v[176:179], v[44:47], v[168:171], v[176:179]
  v_mfma_f32_16x16x32_bf16 v[184:187], v[28:31], v[168:171], v[184:187]
  s_nop 4
  v_cvt_pk_bf16_f32 v80, v172, v180
  v_cvt_pk_bf16_f32 v84, v173, v181
  s_waitcnt lgkmcnt(1)
  v_mfma_f32_16x16x32_bf16 v[228:231], v[44:47], v[220:223], v[228:231]
  v_cvt_pk_bf16_f32 v88, v174, v182
  v_cvt_pk_bf16_f32 v92, v175, v183
  v_mfma_f32_16x16x32_bf16 v[236:239], v[28:31], v[220:223], v[236:239]
  v_cvt_pk_bf16_f32 v82, v176, v184
  v_cvt_pk_bf16_f32 v86, v177, v185
  s_waitcnt lgkmcnt(0)
  v_mfma_f32_16x16x32_bf16 v[232:235], v[44:47], v[224:227], v[232:235]
  v_cvt_pk_bf16_f32 v90, v178, v186
  v_cvt_pk_bf16_f32 v94, v179, v187
  v_mfma_f32_16x16x32_bf16 v[240:243], v[28:31], v[224:227], v[240:243]
  s_nop 0
  v_cvt_pk_bf16_f32 v81, v228, v236
  v_cvt_pk_bf16_f32 v85, v229, v237
  v_cvt_pk_bf16_f32 v89, v230, v238
  v_cvt_pk_bf16_f32 v93, v231, v239
  s_nop 2
  v_cvt_pk_bf16_f32 v83, v232, v240
  buffer_store_dwordx4 v[80:83], v137, s[24:27], s40 offen sc1
  v_cvt_pk_bf16_f32 v87, v233, v241
  v_cvt_pk_bf16_f32 v91, v234, v242
  v_cvt_pk_bf16_f32 v95, v235, v243
  buffer_store_dwordx4 v[84:87], v137, s[24:27], s41 offen sc1
  buffer_store_dwordx4 v[88:91], v137, s[24:27], s42 offen sc1
  buffer_store_dwordx4 v[92:95], v137, s[24:27], s43 offen sc1
  s_nop 1
JOIN:
  s_load_dwordx2 s[6:7], s[0:1], 64
  v_and_b32 v1, 15, v0
  v_bfe_u32 v2, v0, 4, 2
  v_and_b32 v40, 63, v0
  v_lshlrev_b32 v3, 4, v40
  s_and_b32 s9, s45, 7
  s_lshr_b32 s8, s45, 3
  s_lshl_b32 s28, s9, 3
  s_lshr_b32 s29, s8, 2
  s_add_u32 s28, s28, s29
  s_and_b32 s29, s8, 3
  s_and_b32 s30, s3, 1
  s_lshr_b32 s31, s3, 1
  s_xor_b32 s32, s30, s31
  s_mul_i32 s34, s3, 10240
  s_mul_i32 s35, s28, 40960
  s_add_u32 s36, s35, s34
  s_add_u32 s36, s36, 7864320
  v_lshrrev_b32 v4, 1, v2
  v_lshl_add_u32 v4, v4, 4, v1
  v_lshlrev_b32 v8, 4, v4
  v_add_u32 v15, 0x10000, v3
  v_add_u32 v16, 0x20000, v3
  v_mov_b32 v9, 1
  v_mov_b32 v12, 0
  s_and_b32 s33, s2, 15
  s_lshl_b32 s33, s33, 7
  v_lshl_add_u32 v41, v1, 11, s33
  v_lshlrev_b32 v10, 7, v1
  s_lshr_b32 s33, s2, 4
  s_lshl_b32 s33, s33, 11
  v_add_u32 v10, s33, v10
  s_mov_b32 s23, 37118464
  s_mov_b32 s69, 37184000
  s_mov_b32 s21, 37151232
  s_cmp_lt_u32 s2, 160
  s_cselect_b32 s20, s23, s69
  s_lshr_b32 s37, s29, 1
  s_add_u32 s37, s37, 1
  s_sub_u32 s33, 0, s37
  s_bitcmp1_b32 s29, 0
  s_cselect_b32 s37, s33, s37
  s_lshl_b32 s38, s29, 1
  s_add_u32 s38, s38, s30
  s_mul_i32 s19, s3, 5120
  v_add_u32 v17, s19, v3
  v_add_u32 v18, s19, v15
  v_add_u32 v19, s19, v16
  s_lshl_b32 s33, s9, 3
  s_lshr_b32 s35, s8, 3
  s_lshl_b32 s35, s35, 1
  s_add_u32 s33, s33, s35
  v_and_b32 v13, 3, v1
  v_add3_u32 v13, v13, s33, -1
  s_lshl_b32 s35, s9, 3
  v_max_i32 v13, s35, v13
  s_add_u32 s35, s35, 7
  v_min_i32 v13, s35, v13
  v_lshlrev_b32 v13, 7, v13
  s_lshl_b32 s10, s28, 7
  s_add_u32 s10, s10, 37036544
  s_lshr_b32 s11, s33, 2
  s_lshl_b32 s11, s11, 7
  s_add_u32 s11, s11, 37052928
  s_and_b32 s33, s8, 7
  s_mul_i32 s16, s33, 102400
  s_add_u32 s16, s16, s19
  s_add_u32 s16, s16, 32276480
  s_mul_i32 s18, s33, 245760
  s_add_u32 s18, s18, s19
  s_add_u32 s18, s18, 35061760
  s_and_b32 s33, s8, 15
  s_mul_i32 s17, s33, 122880
  s_add_u32 s17, s17, s19
  s_add_u32 s17, s17, 33095680
  s_mov_b32 s50, -1
  s_mov_b32 s51, 0
  s_mov_b32 s52, 0x00ff00ff
  s_mov_b32 s53, 0x00ff00ff
  s_mov_b32 s54, 0x0000ffff
  s_mov_b32 s55, 0x0000ffff
  s_mov_b32 s56, 0xffff0000
  s_mov_b32 s57, 0xffff0000
  s_mov_b32 s58, 0x00ff00ff
  s_mov_b32 s59, 0xff00ff00
  v_cvt_f32_u32 v140, v1
  v_lshlrev_b32 v4, 2, v2
  v_cvt_f32_u32 v141, v4
  v_and_b32 v4, 4, v4
  v_add_u32 v4, 16, v4
  v_cvt_f32_u32 v142, v4
  v_cndmask_b32 v143, -1.0, 1.0, s[50:51]
  v_mov_b32 v4, 0x40400000
  v_cndmask_b32 v4, v4, 0, s[50:51]
  v_add_f32 v4, v4, v141
  v_mul_f32 v145, 0x3d800000, v140
  v_mul_f32 v144, v4, v145
  v_mul_f32 v145, v145, v143
  v_fmamk_f32 v148, v145, 0x00000000, v144
  v_cos_f32 v149, v148
  v_sin_f32 v150, v148
  v_fmamk_f32 v152, v145, 0x3f800000, v144
  v_mul_f32 v148, v143, v150
  v_cos_f32 v153, v152
  v_sin_f32 v154, v152
  v_mul_f32 v151, v143, v149
  v_cvt_pk_bf16_f32 v44, v149, -v148
  v_mul_f32 v152, v143, v154
  v_cvt_pk_bf16_f32 v48, v150, v151
  v_fmamk_f32 v148, v145, 0x40000000, v144
  v_cvt_pk_bf16_f32 v45, v153, -v152
  v_cos_f32 v149, v148
  v_sin_f32 v150, v148
  v_fmamk_f32 v152, v145, 0x40400000, v144
  v_mul_f32 v151, v143, v149
  v_mul_f32 v148, v143, v150
  v_mul_f32 v145, 0x3acccccd, v140
  v_cvt_pk_bf16_f32 v46, v149, -v148
  v_cvt_pk_bf16_f32 v50, v150, v151
  v_mul_f32 v144, v145, v141
  v_fmamk_f32 v148, v145, 0x00000000, v144
  v_fmamk_f32 v149, v145, 0x3f800000, v144
  v_fmamk_f32 v150, v145, 0x40000000, v144
  v_fmamk_f32 v151, v145, 0x40400000, v144
  v_cos_f32 v52, v148
  v_sin_f32 v56, v148
  v_cos_f32 v53, v149
  v_sin_f32 v57, v149
  v_cos_f32 v54, v150
  v_sin_f32 v58, v150
  v_cos_f32 v55, v151
  v_sin_f32 v59, v151
  v_mul_f32 v155, v143, v153
  v_mul_f32 v144, v145, v142
  v_cvt_pk_bf16_f32 v49, v154, v155
  v_fmamk_f32 v148, v145, 0x00000000, v144
  v_fmamk_f32 v149, v145, 0x3f800000, v144
  v_fmamk_f32 v150, v145, 0x40000000, v144
  v_fmamk_f32 v151, v145, 0x40400000, v144
  v_cos_f32 v153, v152
  v_sin_f32 v154, v152
  v_add_f32 v145, 0x00000000, v140
  v_mul_f32 v152, v143, v154
  v_mul_f32 v145, 0x3ccccccd, v145
  v_cos_f32 v60, v148
  v_sin_f32 v64, v148
  v_mul_f32 v155, v143, v153
  v_cvt_pk_bf16_f32 v47, v153, -v152
  v_mul_f32 v144, v145, v141
  v_cos_f32 v61, v149
  v_sin_f32 v65, v149
  v_cos_f32 v62, v150
  v_sin_f32 v66, v150
  v_cvt_pk_bf16_f32 v51, v154, v155
  v_fmamk_f32 v148, v145, 0x00000000, v144
  v_fmamk_f32 v152, v145, 0x3f800000, v144
  v_cos_f32 v149, v148
  v_sin_f32 v150, v148
  v_cos_f32 v153, v152
  v_sin_f32 v154, v152
  v_cvt_pk_bf16_f32 v68, v149, -v150
  v_cvt_pk_bf16_f32 v69, v153, -v154
  v_fmamk_f32 v148, v145, 0x40000000, v144
  v_fmamk_f32 v152, v145, 0x40400000, v144
  v_cos_f32 v149, v148
  v_sin_f32 v150, v148
  v_cos_f32 v153, v152
  v_sin_f32 v154, v152
  v_mul_f32 v144, v145, v142
  v_cvt_pk_bf16_f32 v70, v149, -v150
  v_cvt_pk_bf16_f32 v71, v153, -v154
  v_fmamk_f32 v148, v145, 0x00000000, v144
  v_fmamk_f32 v152, v145, 0x3f800000, v144
  v_cos_f32 v149, v148
  v_sin_f32 v150, v148
  v_cos_f32 v153, v152
  v_sin_f32 v154, v152
  v_cos_f32 v63, v151
  v_sin_f32 v67, v151
  v_fmamk_f32 v148, v145, 0x40000000, v144
  v_fmamk_f32 v152, v145, 0x40400000, v144
  v_add_f32 v145, 0x41800000, v140
  v_cvt_pk_bf16_f32 v151, v149, -v150
  v_cvt_pk_bf16_f32 v155, v153, -v154
  v_mul_f32 v145, 0x3ccccccd, v145
  v_cos_f32 v149, v148
  v_sin_f32 v150, v148
  v_cos_f32 v153, v152
  v_sin_f32 v154, v152
  v_cndmask_b32 v84, 0, v151, s[50:51]
  v_cndmask_b32 v92, v151, 0, s[50:51]
  v_cndmask_b32 v85, 0, v155, s[50:51]
  v_cndmask_b32 v93, v155, 0, s[50:51]
  v_mul_f32 v144, v145, v141
  v_cvt_pk_bf16_f32 v151, v149, -v150
  v_cvt_pk_bf16_f32 v155, v153, -v154
  v_fmamk_f32 v148, v145, 0x00000000, v144
  v_fmamk_f32 v152, v145, 0x3f800000, v144
  v_cos_f32 v149, v148
  v_sin_f32 v150, v148
  v_cos_f32 v153, v152
  v_sin_f32 v154, v152
  v_cvt_pk_bf16_f32 v72, v149, -v150
  v_cvt_pk_bf16_f32 v73, v153, -v154
  v_fmamk_f32 v148, v145, 0x40000000, v144
  v_fmamk_f32 v152, v145, 0x40400000, v144
  v_cos_f32 v149, v148
  v_sin_f32 v150, v148
  v_cos_f32 v153, v152
  v_sin_f32 v154, v152
  v_mul_f32 v144, v145, v142
  v_cvt_pk_bf16_f32 v74, v149, -v150
  v_cvt_pk_bf16_f32 v75, v153, -v154
  v_fmamk_f32 v148, v145, 0x00000000, v144
  v_fmamk_f32 v152, v145, 0x3f800000, v144
  v_cos_f32 v149, v148
  v_sin_f32 v150, v148
  v_cos_f32 v153, v152
  v_sin_f32 v154, v152
  v_cndmask_b32 v86, 0, v151, s[50:51]
  v_cndmask_b32 v94, v151, 0, s[50:51]
  v_cndmask_b32 v87, 0, v155, s[50:51]
  v_cndmask_b32 v95, v155, 0, s[50:51]
  v_cvt_pk_bf16_f32 v151, v149, -v150
  v_cvt_pk_bf16_f32 v155, v153, -v154
  v_fmamk_f32 v148, v145, 0x40000000, v144
  v_fmamk_f32 v152, v145, 0x40400000, v144
  v_cos_f32 v149, v148
  v_sin_f32 v150, v148
  v_cos_f32 v153, v152
  v_sin_f32 v154, v152
  v_mov_b32 v147, 0x35cccccd
  v_mov_b32 v4, 0x354ccccd
  v_cndmask_b32 v88, 0, v151, s[50:51]
  v_cndmask_b32 v96, v151, 0, s[50:51]
  v_cndmask_b32 v89, 0, v155, s[50:51]
  v_cndmask_b32 v97, v155, 0, s[50:51]
  v_cndmask_b32 v146, v147, v4, s[56:57]
  v_cndmask_b32 v143, v147, 0, s[56:57]
  v_cvt_pk_bf16_f32 v151, v149, -v150
  v_cvt_pk_bf16_f32 v155, v153, -v154
  v_mul_f32 v52, v147, v52
  v_mul_f32 v56, v147, v56
  v_mul_f32 v53, v147, v53
  v_mul_f32 v57, v147, v57
  v_mul_f32 v54, v147, v54
  v_mul_f32 v58, v147, v58
  v_mul_f32 v55, v147, v55
  v_mul_f32 v59, v147, v59
  v_mul_f32 v60, v146, v60
  v_mul_f32 v64, v146, v64
  v_mul_f32 v61, v143, v61
  v_mul_f32 v65, v143, v65
  v_mul_f32 v62, v143, v62
  v_mul_f32 v66, v143, v66
  v_mul_f32 v63, v143, v63
  v_mul_f32 v67, v143, v67
  v_cndmask_b32 v90, 0, v151, s[50:51]
  v_cndmask_b32 v98, v151, 0, s[50:51]
  v_cndmask_b32 v91, 0, v155, s[50:51]
  v_cndmask_b32 v99, v155, 0, s[50:51]
  s_waitcnt vmcnt(0)
  s_barrier
  s_mov_b64 exec, s[62:63]
  buffer_atomic_add v9, v41, s[24:27], s20 offen sc1
  s_mov_b64 exec, -1
  v_accvgpr_read_b32 v11, a254
  v_cmp_gt_u32 vcc, 6, v11
  s_nop 4
  s_cbranch_vccz CHK3_OUT
  s_mov_b64 exec, 0xffff
  s_movk_i32 s22, 0x7fff
CHK3:
  v_mov_b32 v11, 0
  buffer_atomic_add v11, v10, s[24:27], s21 offen sc0 sc1
  s_waitcnt vmcnt(0)
  v_cmp_gt_u32 vcc, 6, v11
  s_sub_u32 s22, s22, 1
  s_cbranch_scc1 CHK3_END
  s_cbranch_vccnz CHK3
CHK3_END:
  s_mov_b64 exec, -1
CHK3_OUT:
  s_nop 4
  s_barrier
  buffer_load_dwordx4 a[0:3], v3, s[24:27], s39 offen offset:0 sc1
  v_and_b32 v4, 7, v1
  v_add_u32 v4, 32, v4
  v_cvt_f32_u32 v145, v4
  v_and_b32 v4, 1, v1
  v_lshlrev_b32 v4, 4, v4
  v_mov_b32 v5, 0x3f80
  v_lshlrev_b32 v5, v4, v5
  v_lshrrev_b32 v4, 1, v1
  v_lshlrev_b32 v6, 2, v2
  v_sub_u32 v4, v4, v6
  v_cmp_eq_u32 vcc, 0, v4
  v_mul_f32 v145, 0x3ccccccd, v145
  v_mul_f32 v144, v145, v141
  v_cndmask_b32 v104, 0, v5, vcc
  buffer_load_dwordx4 a[4:7], v3, s[24:27], s39 offen offset:1024 sc1
  v_cmp_eq_u32 vcc, -8, v4
  v_fmamk_f32 v148, v145, 0x00000000, v144
  v_fmamk_f32 v152, v145, 0x3f800000, v144
  v_cndmask_b32 v108, 0, v5, vcc
  v_cmp_eq_u32 vcc, 1, v4
  v_cos_f32 v149, v148
  s_nop 0
  v_cndmask_b32 v105, 0, v5, vcc
  v_cmp_eq_u32 vcc, -7, v4
  v_sin_f32 v150, v148
  s_nop 0
  v_cndmask_b32 v109, 0, v5, vcc
  v_cmp_eq_u32 vcc, 2, v4
  v_cos_f32 v153, v152
  buffer_load_dwordx4 a[8:11], v3, s[24:27], s39 offen offset:2048 sc1
  v_sin_f32 v154, v152
  v_cndmask_b32 v106, 0, v5, vcc
  v_cmp_eq_u32 vcc, -6, v4
  v_cvt_pk_bf16_f32 v151, v149, -v150
  v_cvt_pk_bf16_f32 v155, v153, -v154
  v_fmamk_f32 v148, v145, 0x40000000, v144
  v_fmamk_f32 v152, v145, 0x40400000, v144
  v_cos_f32 v149, v148
  v_sin_f32 v150, v148
  v_cos_f32 v153, v152
  v_sin_f32 v154, v152
  buffer_load_dwordx4 a[12:15], v3, s[24:27], s39 offen offset:3072 sc1
  s_add_u32 s39, s39, 4096
  v_cndmask_b32 v76, 0, v151, s[52:53]
  v_cndmask_b32 v80, v151, 0, s[52:53]
  v_cndmask_b32 v77, 0, v155, s[52:53]
  v_cndmask_b32 v81, v155, 0, s[52:53]
  v_mul_f32 v144, v145, v142
  v_cndmask_b32 v110, 0, v5, vcc
  v_cvt_pk_bf16_f32 v151, v149, -v150
  v_cvt_pk_bf16_f32 v155, v153, -v154
  v_fmamk_f32 v148, v145, 0x00000000, v144
  v_fmamk_f32 v152, v145, 0x3f800000, v144
  v_cmp_eq_u32 vcc, 3, v4
  v_cos_f32 v149, v148
  buffer_load_dwordx4 a[16:19], v3, s[24:27], s39 offen offset:0 sc1
  v_sin_f32 v150, v148
  v_cos_f32 v153, v152
  v_sin_f32 v154, v152
  v_cndmask_b32 v78, 0, v151, s[52:53]
  v_cndmask_b32 v82, v151, 0, s[52:53]
  v_cndmask_b32 v79, 0, v155, s[52:53]
  v_cndmask_b32 v83, v155, 0, s[52:53]
  v_cvt_pk_bf16_f32 v151, v149, -v150
  v_cvt_pk_bf16_f32 v155, v153, -v154
  v_fmamk_f32 v148, v145, 0x40000000, v144
  v_fmamk_f32 v152, v145, 0x40400000, v144
  v_cndmask_b32 v107, 0, v5, vcc
  buffer_load_dwordx4 a[20:23], v3, s[24:27], s39 offen offset:1024 sc1
  v_cos_f32 v149, v148
  v_sin_f32 v150, v148
  v_cos_f32 v153, v152
  v_sin_f32 v154, v152
  v_cmp_eq_u32 vcc, -5, v4
  v_cndmask_b32 v100, 0, v151, s[58:59]
  v_cndmask_b32 v101, 0, v155, s[58:59]
  v_cvt_pk_bf16_f32 v151, v149, -v150
  v_cvt_pk_bf16_f32 v155, v153, -v154
  v_cndmask_b32 v102, 0, v151, s[58:59]
  v_cndmask_b32 v103, 0, v155, s[58:59]
  buffer_load_dwordx4 a[24:27], v3, s[24:27], s39 offen offset:2048 sc1
  v_cndmask_b32 v111, 0, v5, vcc
  buffer_load_dwordx4 a[28:31], v3, s[24:27], s39 offen offset:3072 sc1
  s_add_u32 s39, s39, 4096
  buffer_load_dwordx4 a[32:35], v3, s[24:27], s39 offen offset:0 sc1
  buffer_load_dwordx4 a[36:39], v3, s[24:27], s39 offen offset:1024 sc1
  buffer_load_dwordx4 a[40:43], v3, s[24:27], s39 offen offset:2048 sc1
  buffer_load_dwordx4 a[44:47], v3, s[24:27], s39 offen offset:3072 sc1
  s_add_u32 s39, s39, 4096
  v_mov_b32 v11, -1
  s_mov_b64 exec, s[62:63]
  v_mov_b32 v11, 0
  buffer_atomic_add v11, v10, s[24:27], s23 offen sc0 sc1
  s_mov_b64 exec, -1
  buffer_load_dwordx4 a[48:51], v3, s[24:27], s39 offen offset:0 sc1
  v_subrev_u32 v4, 1, v1
  v_sub_u32 v5, 39, v1
  v_cndmask_b32 v4, v5, v4, s[50:51]
  v_sub_u32 v5, 3, v2
  v_cndmask_b32 v5, v5, v2, s[50:51]
  v_mul_u32_u24 v5, 80, v5
  v_add_u32 v5, v5, v4
  v_and_b32 v4, 15, v4
  v_lshlrev_b32 v4, 4, v4
  v_lshl_add_u32 v32, v5, 8, v4
  v_mov_b32 v4, 0x40000
  s_mov_b32 s60, 0x00010001
  s_mov_b32 s61, 0
  v_cndmask_b32 v32, v32, v4, s[60:61]
  buffer_load_dwordx4 a[52:55], v3, s[24:27], s39 offen offset:1024 sc1
  v_and_b32 v6, 7, v1
  v_add_u32 v6, 16, v6
  v_subrev_u32 v4, 1, v6
  v_sub_u32 v5, 39, v6
  v_cndmask_b32 v4, v5, v4, s[50:51]
  v_sub_u32 v5, 3, v2
  v_cndmask_b32 v5, v5, v2, s[50:51]
  v_mul_u32_u24 v5, 80, v5
  v_add_u32 v5, v5, v4
  v_and_b32 v4, 15, v4
  v_lshrrev_b32 v7, 3, v1
  v_lshlrev_b32 v4, 4, v4
  v_and_b32 v6, 7, v1
  buffer_load_dwordx4 a[56:59], v3, s[24:27], s39 offen offset:2048 sc1
  buffer_load_dwordx4 a[60:63], v3, s[24:27], s39 offen offset:3072 sc1
  s_add_u32 s39, s39, 4096
  buffer_load_dwordx4 a[64:67], v3, s[24:27], s39 offen offset:0 sc1
  buffer_load_dwordx4 a[68:71], v3, s[24:27], s39 offen offset:1024 sc1
  buffer_load_dwordx4 a[72:75], v3, s[24:27], s39 offen offset:2048 sc1
  buffer_load_dwordx4 a[76:79], v3, s[24:27], s39 offen offset:3072 sc1
  s_add_u32 s39, s39, 4096
  s_lshl_b32 s40, s3, 3
  s_sub_u32 s40, s40, s37
  s_lshl_b32 s40, s40, 3
  s_add_u32 s33, s40, 0
  s_and_b32 s33, s33, 0xf8
  v_xor_b32 v20, s33, v32
  s_add_u32 s33, s40, 8
  s_and_b32 s33, s33, 0xf8
  v_xor_b32 v21, s33, v32
  s_add_u32 s33, s40, 16
  s_and_b32 s33, s33, 0xf8
  v_xor_b32 v22, s33, v32
  s_add_u32 s33, s40, 24
  s_and_b32 s33, s33, 0xf8
  v_xor_b32 v23, s33, v32
  s_add_u32 s33, s40, 32
  s_and_b32 s33, s33, 0xf8
  v_xor_b32 v24, s33, v32
  s_add_u32 s33, s40, 40
  s_and_b32 s33, s33, 0xf8
  v_xor_b32 v25, s33, v32
  s_add_u32 s33, s40, 48
  s_and_b32 s33, s33, 0xf8
  v_xor_b32 v26, s33, v32
  s_add_u32 s33, s40, 56
  s_and_b32 s33, s33, 0xf8
  v_xor_b32 v27, s33, v32
  v_lshl_add_u32 v7, v7, 5, s40
  v_lshl_add_u32 v32, v5, 8, v4
  v_add_u32 v4, 0, v7
  v_and_b32 v4, 0xf8, v4
  v_xor_b32 v28, v4, v32
  v_add_u32 v4, 8, v7
  v_and_b32 v4, 0xf8, v4
  v_xor_b32 v29, v4, v32
  v_add_u32 v4, 16, v7
  v_and_b32 v4, 0xf8, v4
  v_xor_b32 v30, v4, v32
  s_bitcmp1_b32 s29, 0
  v_add_u32 v4, 24, v7
  s_cselect_b32 s33, 0, 15
  s_cselect_b32 s41, 1, -1
  v_and_b32 v4, 0xf8, v4
  s_add_u32 s41, s41, s28
  v_xor_b32 v31, v4, v32
  s_max_i32 s41, s41, 0
  v_min_u32 v4, 39, v40
  s_min_i32 s41, s41, 63
  v_and_b32 v5, 15, v4
  s_mul_i32 s41, s41, 40960
  v_xor_b32 v5, s33, v5
  s_add_u32 s41, s41, 7864320
  v_lshlrev_b32 v5, 4, v5
  s_cmp_lg_u32 s29, 0
  v_lshl_add_u32 v5, v4, 8, v5
  s_cselect_b64 s[42:43], -1, 0
  v_add_u32 v33, s34, v5
  s_cmp_lg_u32 s29, 1
  v_and_b32 v5, 1, v2
  s_cselect_b64 s[44:45], -1, 0
  s_mul_i32 s33, s31, 20480
  v_lshrrev_b32 v4, 1, v2
  v_lshlrev_b32 v5, 3, v5
  s_add_u32 s33, s33, 40960
  v_lshl_add_u32 v4, v4, 8, v5
  s_lshl_b32 s40, s30, 3
  v_add_u32 v4, s33, v4
  v_xor_b32 v5, s40, v1
  v_lshl_add_u32 v5, v5, 4, v4
  v_lshl_add_u32 v112, v1, 9, v5
  v_lshrrev_b32 v5, 3, v1
  v_lshlrev_b32 v5, 2, v5
  v_xor_b32 v5, v5, v6
  v_xor_b32 v5, s40, v5
  v_lshl_add_u32 v5, v5, 4, v4
  v_lshl_add_u32 v120, v6, 9, v5
  v_xor_b32 v113, 16, v112
  v_xor_b32 v114, 32, v112
  v_xor_b32 v115, 48, v112
  v_xor_b32 v116, 64, v112
  v_xor_b32 v117, 80, v112
  v_xor_b32 v118, 96, v112
  v_xor_b32 v119, 112, v112
  v_xor_b32 v121, 16, v120
  v_xor_b32 v122, 32, v120
  v_xor_b32 v123, 48, v120
  s_waitcnt vmcnt(8)
  v_cmp_gt_u32 vcc, 10, v11
  s_nop 4
  s_cbranch_vccz CHK4_OUT
  s_mov_b64 exec, 0xffff
  s_movk_i32 s22, 0x7fff
CHK4:
  v_mov_b32 v11, 0
  buffer_atomic_add v11, v10, s[24:27], s23 offen sc0 sc1
  s_waitcnt vmcnt(0)
  v_cmp_gt_u32 vcc, 10, v11
  s_sub_u32 s22, s22, 1
  s_cbranch_scc1 CHK4_END
  s_cbranch_vccnz CHK4
CHK4_END:
  s_mov_b64 exec, -1
CHK4_OUT:
  s_nop 4
  s_barrier
  s_add_u32 m0, s34, 0
  s_nop 0
  buffer_load_dwordx4 v3, s[24:27], s36 offen offset:0 sc1 lds
  buffer_load_dwordx4 v3, s[24:27], s36 offen offset:1024 sc1 lds
  buffer_load_dwordx4 v3, s[24:27], s36 offen offset:2048 sc1 lds
  buffer_load_dwordx4 v3, s[24:27], s36 offen offset:3072 sc1 lds
  s_add_u32 s36, s36, 4096
  s_add_u32 m0, s34, 4096
  s_nop 0
  buffer_load_dwordx4 v3, s[24:27], s36 offen offset:0 sc1 lds
  buffer_load_dwordx4 v3, s[24:27], s36 offen offset:1024 sc1 lds
  buffer_load_dwordx4 v3, s[24:27], s36 offen offset:2048 sc1 lds
  buffer_load_dwordx4 v3, s[24:27], s36 offen offset:3072 sc1 lds
  s_add_u32 s36, s36, 4096
  s_add_u32 m0, s34, 8192
  s_nop 0
  buffer_load_dwordx4 v3, s[24:27], s36 offen offset:0 sc1 lds
  buffer_load_dwordx4 v3, s[24:27], s36 offen offset:1024 sc1 lds
  buffer_load_dwordx4 v[36:39], v33, s[24:27], s41 offen sc1
  s_lshl_b32 s33, s9, 7
  s_add_u32 s33, s33, 37044736
  buffer_load_dword v41, v12, s[24:27], s33 offen sc1
  v_bfrev_b32 v14, 1
  v_cndmask_b32 v14, v14, 0, s[62:63]
  v_or_b32 v40, v14, v10
  v_mov_b32 v11, 0
  buffer_load_dwordx4 a[80:83], v3, s[24:27], s39 offen offset:0 sc1
  buffer_load_dwordx4 a[84:87], v3, s[24:27], s39 offen offset:1024 sc1
  buffer_load_dwordx4 a[88:91], v3, s[24:27], s39 offen offset:2048 sc1
  buffer_load_dwordx4 a[92:95], v3, s[24:27], s39 offen offset:3072 sc1
  s_add_u32 s39, s39, 4096
  buffer_load_dwordx4 a[96:99], v3, s[24:27], s39 offen offset:0 sc1
  buffer_load_dwordx4 a[100:103], v3, s[24:27], s39 offen offset:1024 sc1
  buffer_load_dwordx4 a[104:107], v3, s[24:27], s39 offen offset:2048 sc1
  buffer_load_dwordx4 a[108:111], v3, s[24:27], s39 offen offset:3072 sc1
  s_add_u32 s39, s39, 4096
  s_getpc_b64 s[4:5]
PF3:
  v_lshlrev_b32 v4, 7, v0
  v_min_u32 v4, C_P5-PF3, v4
  global_load_dword a241, v4, s[4:5]
  s_waitcnt vmcnt(10)
  s_mov_b64 exec, s[42:43]
  ds_write_b64 v33, v[36:37] offset:0
  s_mov_b64 exec, s[44:45]
  ds_write_b64 v33, v[38:39] offset:8
  s_mov_b64 exec, -1
  s_waitcnt lgkmcnt(0)
  s_barrier
  s_add_u32 s12, s10, 40960
  s_and_b32 exec_lo, s62, 1
  s_mov_b32 exec_hi, 0
  buffer_atomic_add v9, v12, s[24:27], s12 offen sc1
  s_mov_b64 exec, -1
  buffer_load_dwordx4 a[112:115], v3, s[24:27], s39 offen offset:0 sc1
  s_mov_b32 s68, 18350080
  ds_read2st64_b64 v[140:143], v20 offset0:0 offset1:20
  ds_read2st64_b64 v[144:147], v24 offset0:0 offset1:20
  ds_read2st64_b64 v[148:151], v28 offset0:0 offset1:20
  ds_read2st64_b64 v[152:155], v21 offset0:0 offset1:20
  ds_read2st64_b64 v[156:159], v25 offset0:0 offset1:20
  ds_read2st64_b64 v[160:163], v29 offset0:0 offset1:20
  v_mfma_f32_16x16x32_bf16 v[212:215], v[104:107], a[200:203], 0
  s_waitcnt vmcnt(11)
  v_readfirstlane_b32 s33, v41
  s_mul_i32 s41, s31, 10240
  s_bcnt1_i32_b32 s33, s33
  s_cmp_eq_u32 s33, 1
  s_cselect_b32 s56, 0, 0x80000000
  s_cselect_b32 s57, 0x80000000, 0
  buffer_load_dwordx4 a[116:119], v3, s[24:27], s39 offen offset:1024 sc1
  s_cselect_b32 s68, 7864320, s68
  v_mfma_f32_16x16x32_bf16 v[228:231], v[104:107], a[232:235], 0
  s_mul_i32 s42, s32, 20480
  v_lshrrev_b32 v4, 1, v2
  v_mfma_f32_16x16x32_bf16 v[216:219], v[108:111], a[200:203], 0
  v_xor_b32 v4, v4, v1
  v_lshlrev_b32 v4, 4, v4
  v_mfma_f32_16x16x32_bf16 v[220:223], v[104:107], a[216:219], 0
  v_lshl_add_u32 v4, v2, 8, v4
  s_mov_b32 s13, 23592960
  v_mfma_f32_16x16x32_bf16 v[224:227], v[108:111], a[216:219], 0
  buffer_load_dwordx4 a[120:123], v3, s[24:27], s39 offen offset:2048 sc1
  s_waitcnt lgkmcnt(5)
  v_mfma_f32_16x16x32_bf16 v[164:167], v[140:143], v[44:47], 0
  v_mfma_f32_16x16x32_bf16 v[168:171], v[140:143], v[48:51], 0
  ds_read2st64_b64 v[140:143], v22 offset0:0 offset1:20
  s_waitcnt lgkmcnt(5)
  v_mfma_f32_16x16x32_bf16 v[172:175], v[144:147], v[44:47], 0
  s_nop 3
  v_mul_f32 v232, v164, v52
  v_mul_f32 v233, v165, v53
  v_mfma_f32_16x16x32_bf16 v[176:179], v[144:147], v[48:51], 0
  buffer_load_dwordx4 a[124:127], v3, s[24:27], s39 offen offset:3072 sc1
  s_add_u32 s39, s39, 4096
  s_waitcnt lgkmcnt(4)
  v_mfma_f32_16x16x32_bf16 v[180:183], v[148:151], v[44:47], 0
  v_mul_f32 v236, v168, v52
  v_mul_f32 v237, v169, v53
  v_mfma_f32_16x16x32_bf16 v[184:187], v[148:151], v[48:51], 0
  v_mul_f32 v234, v166, v54
  v_mul_f32 v238, v170, v54
  v_mul_f32 v235, v167, v55
  v_mul_f32 v239, v171, v55
  v_fma_f32 v232, -v168, v56, v232
  v_fmac_f32 v236, v164, v56
  v_fma_f32 v233, -v169, v57, v233
  v_fmac_f32 v237, v165, v57
  buffer_load_dwordx4 a[128:131], v3, s[24:27], s39 offen offset:0 sc1
  v_fma_f32 v234, -v170, v58, v234
  v_fmac_f32 v238, v166, v58
  v_fma_f32 v235, -v171, v59, v235
  v_fmac_f32 v239, v167, v59
  v_mul_f32 v240, v172, v52
  v_mul_f32 v244, v176, v52
  v_mul_f32 v241, v173, v53
  v_mul_f32 v245, v177, v53
  v_mul_f32 v242, v174, v54
  v_mul_f32 v246, v178, v54
  v_mul_f32 v243, v175, v55
  v_mul_f32 v247, v179, v55
  v_cvt_pk_bf16_f32 v188, v232, v236
  v_cvt_pk_bf16_f32 v189, v233, v237
  buffer_load_dwordx4 a[132:135], v3, s[24:27], s39 offen offset:1024 sc1
  v_cvt_pk_bf16_f32 v190, v234, v238
  v_cvt_pk_bf16_f32 v191, v235, v239
  v_fma_f32 v240, -v176, v56, v240
  v_fmac_f32 v244, v172, v56
  v_fma_f32 v241, -v177, v57, v241
  v_fmac_f32 v245, v173, v57
  v_fma_f32 v242, -v178, v58, v242
  v_fmac_f32 v246, v174, v58
  v_fma_f32 v243, -v179, v59, v243
  v_fmac_f32 v247, v175, v59
  v_mul_f32 v232, v180, v60
  v_mul_f32 v236, v184, v60
  v_mul_f32 v233, v181, v61
  v_mul_f32 v237, v185, v61
  buffer_load_dwordx4 a[136:139], v3, s[24:27], s39 offen offset:2048 sc1
  v_mul_f32 v234, v182, v62
  v_mul_f32 v238, v186, v62
  v_mul_f32 v235, v183, v63
  v_mul_f32 v239, v187, v63
  v_cvt_pk_bf16_f32 v192, v240, v244
  v_cvt_pk_bf16_f32 v193, v241, v245
  v_cvt_pk_bf16_f32 v194, v242, v246
  v_cvt_pk_bf16_f32 v195, v243, v247
  v_fma_f32 v232, -v184, v64, v232
  v_fmac_f32 v236, v180, v64
  v_fma_f32 v233, -v185, v65, v233
  v_fmac_f32 v237, v181, v65
  v_fma_f32 v234, -v186, v66, v234
  v_fmac_f32 v238, v182, v66
  buffer_load_dwordx4 a[140:143], v3, s[24:27], s39 offen offset:3072 sc1
  s_add_u32 s39, s39, 4096
  s_add_u32 m0, s19, 81920
  s_add_u32 s20, s16, 0
  v_fma_f32 v235, -v187, v67, v235
  v_fmac_f32 v239, v183, v67
  v_mfma_f32_16x16x32_bf16 v[212:215], v[188:191], v[68:71], v[212:215]
  v_cvt_pk_bf16_f32 v196, v232, v236
  v_cvt_pk_bf16_f32 v197, v233, v237
  v_mfma_f32_16x16x32_bf16 v[228:231], v[188:191], v[76:79], v[228:231]
  v_cvt_pk_bf16_f32 v198, v234, v238
  v_cvt_pk_bf16_f32 v199, v235, v239
  v_mfma_f32_16x16x32_bf16 v[216:219], v[188:191], v[72:75], v[216:219]
  buffer_load_dwordx4 v3, s[24:27], s20 offen offset:0 sc1 lds
  ds_read2st64_b64 v[144:147], v26 offset0:0 offset1:20
  v_mfma_f32_16x16x32_bf16 v[220:223], v[192:195], v[68:71], v[220:223]
  ds_read2st64_b64 v[148:151], v30 offset0:0 offset1:20
  v_mfma_f32_16x16x32_bf16 v[224:227], v[192:195], v[72:75], v[224:227]
  v_mfma_f32_16x16x32_bf16 v[212:215], v[196:199], v[84:87], v[212:215]
  v_mfma_f32_16x16x32_bf16 v[228:231], v[192:195], v[80:83], v[228:231]
  buffer_load_dwordx4 v3, s[24:27], s20 offen offset:1024 sc1 lds
  v_mfma_f32_16x16x32_bf16 v[216:219], v[196:199], v[88:91], v[216:219]
  s_nop 4
  v_cvt_pk_bf16_f32 v212, v212, v213
  v_cvt_pk_bf16_f32 v213, v214, v215
  v_mfma_f32_16x16x32_bf16 v[220:223], v[196:199], v[92:95], v[220:223]
  ds_write_b64 v112, v[212:213] offset:0
  v_mfma_f32_16x16x32_bf16 v[224:227], v[196:199], v[96:99], v[224:227]
  v_cvt_pk_bf16_f32 v216, v216, v217
  v_cvt_pk_bf16_f32 v217, v218, v219
  v_mfma_f32_16x16x32_bf16 v[228:231], v[196:199], v[100:103], v[228:231]
  buffer_load_dwordx4 v3, s[24:27], s20 offen offset:2048 sc1 lds
  s_nop 1
  v_cvt_pk_bf16_f32 v220, v220, v221
  s_waitcnt lgkmcnt(6)
  v_mfma_f32_16x16x32_bf16 v[164:167], v[152:155], v[44:47], 0
  v_cvt_pk_bf16_f32 v224, v224, v225
  v_cvt_pk_bf16_f32 v221, v222, v223
  v_mfma_f32_16x16x32_bf16 v[168:171], v[152:155], v[48:51], 0
  ds_write_b64 v112, v[216:217] offset:8192
  v_cvt_pk_bf16_f32 v228, v228, v229
  s_waitcnt lgkmcnt(6)
  v_mfma_f32_16x16x32_bf16 v[172:175], v[156:159], v[44:47], 0
  v_cvt_pk_bf16_f32 v225, v226, v227
  ds_write_b64 v116, v[220:221] offset:0
  v_mfma_f32_16x16x32_bf16 v[176:179], v[156:159], v[48:51], 0
  buffer_load_dwordx4 v3, s[24:27], s20 offen offset:3072 sc1 lds
  s_add_u32 m0, s19, 86016
  s_add_u32 s20, s16, 4096
  s_waitcnt lgkmcnt(6)
  v_mfma_f32_16x16x32_bf16 v[180:183], v[160:163], v[44:47], 0
  v_cvt_pk_bf16_f32 v229, v230, v231
  ds_write_b64 v116, v[224:225] offset:8192
  v_mfma_f32_16x16x32_bf16 v[184:187], v[160:163], v[48:51], 0
  v_mul_f32 v240, v164, v52
  v_mul_f32 v244, v168, v52
  v_mul_f32 v241, v165, v53
  v_mul_f32 v245, v169, v53
  v_mul_f32 v242, v166, v54
  v_mul_f32 v246, v170, v54
  v_mul_f32 v243, v167, v55
  buffer_load_dwordx4 v3, s[24:27], s20 offen sc1 lds
  v_mul_f32 v247, v171, v55
  ds_write_b64 v120, v[228:229] offset:16384
  v_fma_f32 v240, -v168, v56, v240
  v_fmac_f32 v244, v164, v56
  v_fma_f32 v241, -v169, v57, v241
  v_fmac_f32 v245, v165, v57
  v_fma_f32 v242, -v170, v58, v242
  v_fmac_f32 v246, v166, v58
  v_fma_f32 v243, -v171, v59, v243
  v_fmac_f32 v247, v167, v59
  v_mfma_f32_16x16x32_bf16 v[212:215], v[104:107], a[204:207], 0
  v_mul_f32 v232, v172, v52
  v_mul_f32 v236, v176, v52
  buffer_load_dwordx4 a[144:147], v3, s[24:27], s39 offen offset:0 sc1
  v_mfma_f32_16x16x32_bf16 v[228:231], v[108:111], a[232:235], 0
  v_mul_f32 v233, v173, v53
  v_mul_f32 v237, v177, v53
  v_mul_f32 v234, v174, v54
  v_mul_f32 v238, v178, v54
  v_mul_f32 v235, v175, v55
  v_mul_f32 v239, v179, v55
  v_cvt_pk_bf16_f32 v200, v240, v244
  v_cvt_pk_bf16_f32 v201, v241, v245
  v_cvt_pk_bf16_f32 v202, v242, v246
  v_cvt_pk_bf16_f32 v203, v243, v247
  v_mfma_f32_16x16x32_bf16 v[216:219], v[108:111], a[204:207], 0
  buffer_load_dwordx4 a[148:151], v3, s[24:27], s39 offen offset:1024 sc1
  v_fma_f32 v232, -v176, v56, v232
  v_fmac_f32 v236, v172, v56
  v_fma_f32 v233, -v177, v57, v233
  v_fmac_f32 v237, v173, v57
  v_fma_f32 v234, -v178, v58, v234
  v_fmac_f32 v238, v174, v58
  v_fma_f32 v235, -v179, v59, v235
  v_fmac_f32 v239, v175, v59
  v_mfma_f32_16x16x32_bf16 v[220:223], v[104:107], a[220:223], 0
  v_mul_f32 v240, v180, v60
  v_mul_f32 v244, v184, v60
  v_mul_f32 v241, v181, v61
  v_mul_f32 v245, v185, v61
  buffer_load_dwordx4 a[152:155], v3, s[24:27], s39 offen offset:2048 sc1
  v_mul_f32 v242, v182, v62
  v_mul_f32 v246, v186, v62
  v_mul_f32 v243, v183, v63
  v_mul_f32 v247, v187, v63
  v_cvt_pk_bf16_f32 v204, v232, v236
  v_cvt_pk_bf16_f32 v205, v233, v237
  v_cvt_pk_bf16_f32 v206, v234, v238
  v_cvt_pk_bf16_f32 v207, v235, v239
  v_mfma_f32_16x16x32_bf16 v[224:227], v[108:111], a[220:223], 0
  v_fma_f32 v240, -v184, v64, v240
  v_fmac_f32 v244, v180, v64
  v_fma_f32 v241, -v185, v65, v241
  v_fmac_f32 v245, v181, v65
  buffer_load_dwordx4 a[156:159], v3, s[24:27], s39 offen offset:3072 sc1
  s_add_u32 s39, s39, 4096
  s_add_u32 m0, s19, 102400
  s_add_u32 s20, s16, 20480
  v_fma_f32 v242, -v186, v66, v242
  v_fmac_f32 v246, v182, v66
  v_fma_f32 v243, -v187, v67, v243
  v_fmac_f32 v247, v183, v67
  v_mfma_f32_16x16x32_bf16 v[212:215], v[200:203], v[68:71], v[212:215]
  v_cvt_pk_bf16_f32 v208, v240, v244
  v_cvt_pk_bf16_f32 v209, v241, v245
  v_mfma_f32_16x16x32_bf16 v[228:231], v[200:203], v[76:79], v[228:231]
  v_cvt_pk_bf16_f32 v210, v242, v246
  v_cvt_pk_bf16_f32 v211, v243, v247
  buffer_load_dwordx4 a[160:163], v3, s[24:27], s39 offen offset:0 sc1
  v_mfma_f32_16x16x32_bf16 v[216:219], v[200:203], v[72:75], v[216:219]
  ds_read2st64_b64 v[152:155], v23 offset0:0 offset1:20
  ds_read2st64_b64 v[156:159], v27 offset0:0 offset1:20
  v_mfma_f32_16x16x32_bf16 v[220:223], v[204:207], v[68:71], v[220:223]
  ds_read2st64_b64 v[160:163], v31 offset0:0 offset1:20
  v_mfma_f32_16x16x32_bf16 v[224:227], v[204:207], v[72:75], v[224:227]
  v_mfma_f32_16x16x32_bf16 v[212:215], v[208:211], v[84:87], v[212:215]
  buffer_load_dwordx4 a[164:167], v3, s[24:27], s39 offen offset:1024 sc1
  v_mfma_f32_16x16x32_bf16 v[228:231], v[204:207], v[80:83], v[228:231]
  v_mfma_f32_16x16x32_bf16 v[216:219], v[208:211], v[88:91], v[216:219]
  s_nop 4
  v_cvt_pk_bf16_f32 v212, v212, v213
  v_cvt_pk_bf16_f32 v213, v214, v215
  v_mfma_f32_16x16x32_bf16 v[220:223], v[208:211], v[92:95], v[220:223]
  ds_write_b64 v113, v[212:213] offset:0
  v_mfma_f32_16x16x32_bf16 v[224:227], v[208:211], v[96:99], v[224:227]
  v_cvt_pk_bf16_f32 v216, v216, v217
  buffer_load_dwordx4 a[168:171], v3, s[24:27], s39 offen offset:2048 sc1
  v_mfma_f32_16x16x32_bf16 v[228:231], v[208:211], v[100:103], v[228:231]
  s_nop 2
  v_cvt_pk_bf16_f32 v220, v220, v221
  v_cvt_pk_bf16_f32 v217, v218, v219
  s_waitcnt lgkmcnt(8)
  v_mfma_f32_16x16x32_bf16 v[164:167], v[140:143], v[44:47], 0
  v_cvt_pk_bf16_f32 v224, v224, v225
  v_cvt_pk_bf16_f32 v221, v222, v223
  v_mfma_f32_16x16x32_bf16 v[168:171], v[140:143], v[48:51], 0
  ds_write_b64 v113, v[216:217] offset:8192
  v_cvt_pk_bf16_f32 v228, v228, v229
  v_mfma_f32_16x16x32_bf16 v[172:175], v[144:147], v[44:47], 0
  v_cvt_pk_bf16_f32 v225, v226, v227
  buffer_load_dwordx4 v3, s[24:27], s20 offen offset:0 sc1 lds
  v_mfma_f32_16x16x32_bf16 v[176:179], v[144:147], v[48:51], 0
  ds_write_b64 v117, v[220:221] offset:0
  v_cvt_pk_bf16_f32 v229, v230, v231
  v_mfma_f32_16x16x32_bf16 v[180:183], v[148:151], v[44:47], 0
  ds_write_b64 v117, v[224:225] offset:8192
  v_mul_f32 v232, v164, v52
  v_mfma_f32_16x16x32_bf16 v[184:187], v[148:151], v[48:51], 0
  v_mul_f32 v236, v168, v52
  v_mul_f32 v233, v165, v53
  v_mul_f32 v237, v169, v53
  v_mul_f32 v234, v166, v54
  v_mul_f32 v238, v170, v54
  buffer_load_dwordx4 v3, s[24:27], s20 offen offset:1024 sc1 lds
  v_mul_f32 v235, v167, v55
  v_mul_f32 v239, v171, v55
  ds_write_b64 v121, v[228:229] offset:16384
  v_fma_f32 v232, -v168, v56, v232
  v_fmac_f32 v236, v164, v56
  v_fma_f32 v233, -v169, v57, v233
  v_fmac_f32 v237, v165, v57
  v_fma_f32 v234, -v170, v58, v234
  v_fmac_f32 v238, v166, v58
  v_fma_f32 v235, -v171, v59, v235
  v_fmac_f32 v239, v167, v59
  v_mfma_f32_16x16x32_bf16 v[212:215], v[104:107], a[208:211], 0
  v_mul_f32 v240, v172, v52
  buffer_load_dwordx4 v3, s[24:27], s20 offen offset:2048 sc1 lds
  v_mfma_f32_16x16x32_bf16 v[228:231], v[104:107], a[236:239], 0
  v_mul_f32 v244, v176, v52
  v_mul_f32 v241, v173, v53
  v_mul_f32 v245, v177, v53
  v_mul_f32 v242, v174, v54
  v_mul_f32 v246, v178, v54
  v_mul_f32 v243, v175, v55
  v_mul_f32 v247, v179, v55
  v_cvt_pk_bf16_f32 v188, v232, v236
  v_cvt_pk_bf16_f32 v189, v233, v237
  v_cvt_pk_bf16_f32 v190, v234, v238
  v_cvt_pk_bf16_f32 v191, v235, v239
  v_mfma_f32_16x16x32_bf16 v[216:219], v[108:111], a[208:211], 0
  buffer_load_dwordx4 v3, s[24:27], s20 offen offset:3072 sc1 lds
  s_add_u32 m0, s19, 106496
  s_add_u32 s20, s16, 24576
  v_fma_f32 v240, -v176, v56, v240
  v_fmac_f32 v244, v172, v56
  v_fma_f32 v241, -v177, v57, v241
  v_fmac_f32 v245, v173, v57
  v_fma_f32 v242, -v178, v58, v242
  v_fmac_f32 v246, v174, v58
  v_fma_f32 v243, -v179, v59, v243
  v_fmac_f32 v247, v175, v59
  v_mfma_f32_16x16x32_bf16 v[220:223], v[104:107], a[224:227], 0
  v_mul_f32 v232, v180, v60
  v_mul_f32 v236, v184, v60
  buffer_load_dwordx4 v3, s[24:27], s20 offen sc1 lds
  v_mul_f32 v233, v181, v61
  v_mul_f32 v237, v185, v61
  v_mul_f32 v234, v182, v62
  v_mul_f32 v238, v186, v62
  v_mul_f32 v235, v183, v63
  v_mul_f32 v239, v187, v63
  v_cvt_pk_bf16_f32 v192, v240, v244
  v_cvt_pk_bf16_f32 v193, v241, v245
  v_cvt_pk_bf16_f32 v194, v242, v246
  v_cvt_pk_bf16_f32 v195, v243, v247
  v_mfma_f32_16x16x32_bf16 v[224:227], v[108:111], a[224:227], 0
  v_fma_f32 v232, -v184, v64, v232
  v_fmac_f32 v236, v180, v64
  buffer_load_dwordx4 a[172:175], v3, s[24:27], s39 offen offset:3072 sc1
  s_add_u32 s39, s39, 4096
  v_fma_f32 v233, -v185, v65, v233
  v_fmac_f32 v237, v181, v65
  v_fma_f32 v234, -v186, v66, v234
  v_fmac_f32 v238, v182, v66
  v_fma_f32 v235, -v187, v67, v235
  v_fmac_f32 v239, v183, v67
  v_mfma_f32_16x16x32_bf16 v[212:215], v[188:191], v[68:71], v[212:215]
  v_cvt_pk_bf16_f32 v196, v232, v236
  v_cvt_pk_bf16_f32 v197, v233, v237
  v_mfma_f32_16x16x32_bf16 v[228:231], v[188:191], v[76:79], v[228:231]
  v_cvt_pk_bf16_f32 v198, v234, v238
  v_cvt_pk_bf16_f32 v199, v235, v239
  buffer_load_dwordx4 a[176:179], v3, s[24:27], s39 offen offset:0 sc1
  v_mfma_f32_16x16x32_bf16 v[216:219], v[188:191], v[72:75], v[216:219]
  v_mfma_f32_16x16x32_bf16 v[220:223], v[192:195], v[68:71], v[220:223]
  v_mfma_f32_16x16x32_bf16 v[224:227], v[192:195], v[72:75], v[224:227]
  v_mfma_f32_16x16x32_bf16 v[212:215], v[196:199], v[84:87], v[212:215]
  buffer_atomic_add v11, v40, s[24:27], s69 offen sc0 sc1
  v_mfma_f32_16x16x32_bf16 v[228:231], v[192:195], v[80:83], v[228:231]
  v_mfma_f32_16x16x32_bf16 v[216:219], v[196:199], v[88:91], v[216:219]
  s_nop 4
  v_cvt_pk_bf16_f32 v212, v212, v213
  buffer_load_dwordx4 a[180:183], v3, s[24:27], s39 offen offset:1024 sc1
  v_mfma_f32_16x16x32_bf16 v[220:223], v[196:199], v[92:95], v[220:223]
  v_cvt_pk_bf16_f32 v213, v214, v215
  ds_write_b64 v114, v[212:213] offset:0
  v_mfma_f32_16x16x32_bf16 v[224:227], v[196:199], v[96:99], v[224:227]
  v_cvt_pk_bf16_f32 v216, v216, v217
  v_cvt_pk_bf16_f32 v217, v218, v219
  v_mfma_f32_16x16x32_bf16 v[228:231], v[196:199], v[100:103], v[228:231]
  s_nop 1
  v_cvt_pk_bf16_f32 v220, v220, v221
  v_cvt_pk_bf16_f32 v221, v222, v223
  s_waitcnt lgkmcnt(5)
  v_mfma_f32_16x16x32_bf16 v[164:167], v[152:155], v[44:47], 0
  v_cvt_pk_bf16_f32 v224, v224, v225
  buffer_load_dwordx4 a[184:187], v3, s[24:27], s39 offen offset:2048 sc1
  v_mfma_f32_16x16x32_bf16 v[168:171], v[152:155], v[48:51], 0
  ds_write_b64 v114, v[216:217] offset:8192
  v_cvt_pk_bf16_f32 v228, v228, v229
  v_mfma_f32_16x16x32_bf16 v[172:175], v[156:159], v[44:47], 0
  v_cvt_pk_bf16_f32 v225, v226, v227
  ds_write_b64 v118, v[220:221] offset:0
  v_mfma_f32_16x16x32_bf16 v[176:179], v[156:159], v[48:51], 0
  v_cvt_pk_bf16_f32 v229, v230, v231
  ds_write_b64 v118, v[224:225] offset:8192
  v_mfma_f32_16x16x32_bf16 v[180:183], v[160:163], v[44:47], 0
  v_mul_f32 v240, v164, v52
  buffer_load_dwordx4 a[188:191], v3, s[24:27], s39 offen offset:3072 sc1
  s_add_u32 s39, s39, 4096
  s_add_u32 m0, s19, 122880
  s_add_u32 s20, s16, 40960
  v_mfma_f32_16x16x32_bf16 v[184:187], v[160:163], v[48:51], 0
  v_mul_f32 v244, v168, v52
  v_mul_f32 v241, v165, v53
  v_mul_f32 v245, v169, v53
  v_mul_f32 v242, v166, v54
  v_mul_f32 v246, v170, v54
  v_mul_f32 v243, v167, v55
  v_mul_f32 v247, v171, v55
  ds_write_b64 v122, v[228:229] offset:16384
  v_fma_f32 v240, -v168, v56, v240
  v_fmac_f32 v244, v164, v56
  buffer_load_dwordx4 a[192:195], v3, s[24:27], s39 offen offset:0 sc1
  v_fma_f32 v241, -v169, v57, v241
  v_fmac_f32 v245, v165, v57
  v_fma_f32 v242, -v170, v58, v242
  v_fmac_f32 v246, v166, v58
  v_fma_f32 v243, -v171, v59, v243
  v_fmac_f32 v247, v167, v59
  v_mfma_f32_16x16x32_bf16 v[212:215], v[104:107], a[212:215], 0
  v_mul_f32 v232, v172, v52
  v_mul_f32 v236, v176, v52
  v_mfma_f32_16x16x32_bf16 v[228:231], v[108:111], a[236:239], 0
  v_mul_f32 v233, v173, v53
  v_mul_f32 v237, v177, v53
  buffer_load_dwordx4 a[196:199], v3, s[24:27], s39 offen offset:1024 sc1
  v_mul_f32 v234, v174, v54
  v_mul_f32 v238, v178, v54
  v_mul_f32 v235, v175, v55
  v_mul_f32 v239, v179, v55
  v_cvt_pk_bf16_f32 v200, v240, v244
  v_cvt_pk_bf16_f32 v201, v241, v245
  v_cvt_pk_bf16_f32 v202, v242, v246
  v_cvt_pk_bf16_f32 v203, v243, v247
  v_mfma_f32_16x16x32_bf16 v[216:219], v[108:111], a[212:215], 0
  v_fma_f32 v232, -v176, v56, v232
  v_fmac_f32 v236, v172, v56
  v_fma_f32 v233, -v177, v57, v233
  v_fmac_f32 v237, v173, v57
  buffer_load_dwordx4 v3, s[24:27], s20 offen offset:0 sc1 lds
  v_fma_f32 v234, -v178, v58, v234
  v_fmac_f32 v238, v174, v58
  v_fma_f32 v235, -v179, v59, v235
  v_fmac_f32 v239, v175, v59
  v_mfma_f32_16x16x32_bf16 v[220:223], v[104:107], a[228:231], 0
  v_mul_f32 v240, v180, v60
  v_mul_f32 v244, v184, v60
  v_mul_f32 v241, v181, v61
  v_mul_f32 v245, v185, v61
  v_mul_f32 v242, v182, v62
  v_mul_f32 v246, v186, v62
  v_mul_f32 v243, v183, v63
  v_mul_f32 v247, v187, v63
  buffer_load_dwordx4 v3, s[24:27], s20 offen offset:1024 sc1 lds
  v_cvt_pk_bf16_f32 v204, v232, v236
  v_cvt_pk_bf16_f32 v205, v233, v237
  v_cvt_pk_bf16_f32 v206, v234, v238
  v_cvt_pk_bf16_f32 v207, v235, v239
  v_mfma_f32_16x16x32_bf16 v[224:227], v[108:111], a[228:231], 0
  v_fma_f32 v240, -v184, v64, v240
  v_fmac_f32 v244, v180, v64
  v_fma_f32 v241, -v185, v65, v241
  v_fmac_f32 v245, v181, v65
  v_fma_f32 v242, -v186, v66, v242
  v_fmac_f32 v246, v182, v66
  v_fma_f32 v243, -v187, v67, v243
  v_fmac_f32 v247, v183, v67
  buffer_load_dwordx4 v3, s[24:27], s20 offen offset:2048 sc1 lds
  v_mfma_f32_16x16x32_bf16 v[212:215], v[200:203], v[68:71], v[212:215]
  v_cvt_pk_bf16_f32 v208, v240, v244
  v_cvt_pk_bf16_f32 v209, v241, v245
  v_mfma_f32_16x16x32_bf16 v[228:231], v[200:203], v[76:79], v[228:231]
  v_cvt_pk_bf16_f32 v210, v242, v246
  v_cvt_pk_bf16_f32 v211, v243, v247
  v_mfma_f32_16x16x32_bf16 v[216:219], v[200:203], v[72:75], v[216:219]
  v_mfma_f32_16x16x32_bf16 v[220:223], v[204:207], v[68:71], v[220:223]
  buffer_load_dwordx4 v3, s[24:27], s20 offen offset:3072 sc1 lds
  s_add_u32 m0, s19, 126976
  s_add_u32 s20, s16, 45056
  s_add_u32 s41, s41, 40960
  s_add_u32 s43, s41, 20480
  s_sub_u32 s43, s43, s42
  s_add_u32 s42, s42, s41
  s_lshl_b32 s44, s31, 6
  s_add_u32 s33, s44, 0
  s_and_b32 s33, s33, 0xf0
  v_xor_b32 v5, s33, v4
  s_add_u32 s33, s44, 32
  v_add_u32 v124, s42, v5
  v_add_u32 v132, s43, v5
  s_and_b32 s33, s33, 0xf0
  v_xor_b32 v5, s33, v4
  buffer_load_dwordx4 v3, s[24:27], s20 offen sc1 lds
  s_add_u32 s33, s44, 64
  v_add_u32 v125, s42, v5
  v_add_u32 v133, s43, v5
  s_and_b32 s33, s33, 0xf0
  v_mfma_f32_16x16x32_bf16 v[224:227], v[204:207], v[72:75], v[224:227]
  v_xor_b32 v5, s33, v4
  s_add_u32 s33, s44, 96
  v_mfma_f32_16x16x32_bf16 v[212:215], v[208:211], v[84:87], v[212:215]
  v_add_u32 v126, s42, v5
  v_add_u32 v134, s43, v5
  v_mfma_f32_16x16x32_bf16 v[228:231], v[204:207], v[80:83], v[228:231]
  s_and_b32 s33, s33, 0xf0
  v_xor_b32 v5, s33, v4
  v_mfma_f32_16x16x32_bf16 v[216:219], v[208:211], v[88:91], v[216:219]
  s_add_u32 s33, s44, 128
  v_add_u32 v127, s42, v5
  v_mfma_f32_16x16x32_bf16 v[220:223], v[208:211], v[92:95], v[220:223]
  v_add_u32 v135, s43, v5
  s_and_b32 s33, s33, 0xf0
  v_mfma_f32_16x16x32_bf16 v[224:227], v[208:211], v[96:99], v[224:227]
  v_xor_b32 v5, s33, v4
  s_add_u32 s33, s44, 160
  v_mfma_f32_16x16x32_bf16 v[228:231], v[208:211], v[100:103], v[228:231]
  v_add_u32 v128, s42, v5
  v_add_u32 v136, s43, v5
  s_and_b32 s33, s33, 0xf0
  v_xor_b32 v5, s33, v4
  s_add_u32 s33, s44, 192
  v_cvt_pk_bf16_f32 v212, v212, v213
  v_add_u32 v129, s42, v5
  v_add_u32 v137, s43, v5
  s_and_b32 s33, s33, 0xf0
  v_cvt_pk_bf16_f32 v216, v216, v217
  v_cvt_pk_bf16_f32 v213, v214, v215
  v_xor_b32 v5, s33, v4
  v_cvt_pk_bf16_f32 v220, v220, v221
  v_cvt_pk_bf16_f32 v217, v218, v219
  ds_write_b64 v115, v[212:213] offset:0
  s_add_u32 s33, s44, 224
  v_cvt_pk_bf16_f32 v224, v224, v225
  v_cvt_pk_bf16_f32 v221, v222, v223
  ds_write_b64 v115, v[216:217] offset:8192
  v_add_u32 v130, s42, v5
  v_add_u32 v138, s43, v5
  s_and_b32 s33, s33, 0xf0
  v_cvt_pk_bf16_f32 v228, v228, v229
  v_cvt_pk_bf16_f32 v225, v226, v227
  ds_write_b64 v119, v[220:221] offset:0
  v_xor_b32 v5, s33, v4
  v_cvt_pk_bf16_f32 v229, v230, v231
  ds_write_b64 v119, v[224:225] offset:8192
  v_add_u32 v131, s42, v5
  v_add_u32 v139, s43, v5
  ds_write_b64 v123, v[228:229] offset:16384
  s_waitcnt vmcnt(10)
  v_or_b32 v11, v14, v11
  v_cmp_gt_u32 vcc, 6, v11
  s_nop 4
  s_cbranch_vccz CHK5_OUT
  s_mov_b64 exec, 0xffff
  s_movk_i32 s22, 0x7fff
CHK5:
  v_mov_b32 v11, 0
  buffer_atomic_add v11, v10, s[24:27], s69 offen sc0 sc1
  s_waitcnt vmcnt(0)
  v_cmp_gt_u32 vcc, 6, v11
  s_sub_u32 s22, s22, 1
  s_cbranch_scc1 CHK5_END
  s_cbranch_vccnz CHK5
CHK5_END:
  s_mov_b64 exec, -1
CHK5_OUT:
  s_nop 4
  s_waitcnt lgkmcnt(0)
  s_barrier
  v_min_u32 v10, 2, v1
  v_add3_u32 v10, v10, s28, -1
  v_med3_i32 v10, v10, 0, 63
  v_lshlrev_b32 v10, 7, v10
  s_mov_b32 s12, 37077504
  s_and_b32 s62, s62, 7
  v_mov_b32 v11, -1
  s_mov_b64 exec, s[62:63]
  v_mov_b32 v11, 0
  buffer_atomic_add v11, v10, s[24:27], s12 offen sc0 sc1
  s_mov_b64 exec, -1
  s_lshr_b32 s35, s8, 4
  s_xor_b32 s35, s35, s29
  s_and_b32 s35, s35, 1
  s_and_b32 s33, s29, 1
  s_lshr_b32 s21, s8, 2
  s_add_u32 s33, s33, s21
  s_cmp_eq_u32 s33, 4
  s_cselect_b32 s21, 0, s35
  s_lshr_b32 s33, s29, 1
  s_xor_b32 s33, s33, s31
  s_or_b32 s33, s33, s21
  s_lshl_b32 s33, s33, 31
  s_lshl_b32 s45, s28, 1
  s_add_u32 s45, s45, s32
  s_mul_i32 s46, s45, 61440
  s_mul_i32 s35, s35, 20480
  s_mul_i32 s21, s38, 320
  ds_read_b128 v[196:199], v132 offset:0
  ds_read_b128 v[192:195], v124 offset:0
  v_add_u32 v240, s33, v3
  s_mul_i32 s33, s31, 10240
  s_add_u32 s47, s46, s33
  s_add_u32 s47, s47, 10506240
  s_add_u32 s47, s47, s35
  s_add_u32 s21, s21, 37027840
  s_add_u32 m0, s19, 143360
  s_add_u32 s20, s16, 61440
  ds_read_b128 v[204:207], v133 offset:1024
  ds_read_b128 v[200:203], v125 offset:1024
  v_lshlrev_b32 v4, 4, v2
  buffer_load_dwordx4 v[68:71], v4, s[24:27], s21 offen offset:0 sc1
  ds_read_b128 v[212:215], v134 offset:2048
  ds_read_b128 v[208:211], v126 offset:2048
  ds_read_b128 v[220:223], v135 offset:3072
  ds_read_b128 v[216:219], v127 offset:3072
  ds_read_b128 v[228:231], v136 offset:4096
  ds_read_b128 v[224:227], v128 offset:4096
  ds_read_b128 v[236:239], v137 offset:5120
  v_mov_b32 v188, 0x3f803f80
  v_mov_b32 v189, 0x3f803f80
  v_mov_b32 v190, 0x3f803f80
  v_mov_b32 v191, 0x3f803f80
  ds_read_b128 v[232:235], v129 offset:5120
  v_add_u32 v241, s19, v3
  s_mov_b32 s60, 0xaaaaaaaa
  s_mov_b32 s61, 0xaaaaaaaa
  buffer_load_dwordx4 v[72:75], v4, s[24:27], s21 offen offset:64 sc1
  s_mov_b32 s62, 0xcccccccc
  s_mov_b32 s63, 0xcccccccc
  s_waitcnt lgkmcnt(8)
  v_mfma_f32_16x16x32_bf16 v[144:147], a[0:3], v[196:199], 0
  s_mul_i32 s46, s45, 20480
  s_mov_b32 s64, 0x00f0000f
  v_mfma_f32_16x16x32_bf16 v[152:155], a[4:7], v[196:199], 0
  s_mov_b32 s65, 0xf0000f00
  v_mfma_f32_16x16x32_bf16 v[160:163], a[8:11], v[196:199], 0
  v_mfma_f32_16x16x32_bf16 v[168:171], a[12:15], v[196:199], 0
  buffer_load_dwordx4 v[76:79], v4, s[24:27], s21 offen offset:128 sc1
  v_mfma_f32_16x16x32_bf16 v[176:179], a[16:19], v[196:199], 0
  ds_read_b128 v[196:199], v138 offset:6144
  v_mfma_f32_16x16x32_bf16 v[140:143], a[0:3], v[192:195], 0
  v_mfma_f32_16x16x32_bf16 v[148:151], a[4:7], v[192:195], 0
  v_mfma_f32_16x16x32_bf16 v[156:159], a[8:11], v[192:195], 0
  buffer_load_dwordx4 v[80:83], v4, s[24:27], s21 offen offset:192 sc1
  v_mfma_f32_16x16x32_bf16 v[164:167], a[12:15], v[192:195], 0
  v_mfma_f32_16x16x32_bf16 v[172:175], a[16:19], v[192:195], 0
  v_mfma_f32_16x16x32_bf16 v[180:183], v[188:191], v[192:195], 0
  v_mfma_f32_16x16x32_bf16 v[184:187], v[192:195], v[192:195], 0
  buffer_load_dwordx4 v[84:87], v4, s[24:27], s21 offen offset:256 sc1
  v_mfma_f32_16x16x32_bf16 v[144:147], a[20:23], v[204:207], v[144:147]
  v_mfma_f32_16x16x32_bf16 v[152:155], a[24:27], v[204:207], v[152:155]
  v_mfma_f32_16x16x32_bf16 v[160:163], a[28:31], v[204:207], v[160:163]
  v_mfma_f32_16x16x32_bf16 v[168:171], a[32:35], v[204:207], v[168:171]
  buffer_load_dwordx4 v3, s[24:27], s20 offen offset:0 sc1 lds
  v_mfma_f32_16x16x32_bf16 v[176:179], a[36:39], v[204:207], v[176:179]
  ds_read_b128 v[204:207], v139 offset:7168
  v_mfma_f32_16x16x32_bf16 v[140:143], a[20:23], v[200:203], v[140:143]
  v_mfma_f32_16x16x32_bf16 v[148:151], a[24:27], v[200:203], v[148:151]
  v_mfma_f32_16x16x32_bf16 v[156:159], a[28:31], v[200:203], v[156:159]
  buffer_load_dwordx4 v3, s[24:27], s20 offen offset:1024 sc1 lds
  v_mfma_f32_16x16x32_bf16 v[164:167], a[32:35], v[200:203], v[164:167]
  v_mfma_f32_16x16x32_bf16 v[172:175], a[36:39], v[200:203], v[172:175]
  v_mfma_f32_16x16x32_bf16 v[180:183], v[188:191], v[200:203], v[180:183]
  v_mfma_f32_16x16x32_bf16 v[184:187], v[200:203], v[200:203], v[184:187]
  buffer_load_dwordx4 v3, s[24:27], s20 offen offset:2048 sc1 lds
  s_waitcnt lgkmcnt(6)
  v_mfma_f32_16x16x32_bf16 v[144:147], a[40:43], v[212:215], v[144:147]
  v_mfma_f32_16x16x32_bf16 v[152:155], a[44:47], v[212:215], v[152:155]
  v_mfma_f32_16x16x32_bf16 v[160:163], a[48:51], v[212:215], v[160:163]
  v_mfma_f32_16x16x32_bf16 v[168:171], a[52:55], v[212:215], v[168:171]
  buffer_load_dwordx4 v3, s[24:27], s20 offen offset:3072 sc1 lds
  s_add_u32 m0, s19, 147456
  s_add_u32 s20, s16, 65536
  v_mfma_f32_16x16x32_bf16 v[176:179], a[56:59], v[212:215], v[176:179]
  ds_read_b128 v[212:215], v132 offset:8192
  v_mfma_f32_16x16x32_bf16 v[140:143], a[40:43], v[208:211], v[140:143]
  v_mfma_f32_16x16x32_bf16 v[148:151], a[44:47], v[208:211], v[148:151]
  v_mfma_f32_16x16x32_bf16 v[156:159], a[48:51], v[208:211], v[156:159]
  buffer_load_dwordx4 v3, s[24:27], s20 offen sc1 lds
  s_add_u32 s20, s17, 61440
  v_mfma_f32_16x16x32_bf16 v[164:167], a[52:55], v[208:211], v[164:167]
  v_mfma_f32_16x16x32_bf16 v[172:175], a[56:59], v[208:211], v[172:175]
  v_mfma_f32_16x16x32_bf16 v[180:183], v[188:191], v[208:211], v[180:183]
  v_mfma_f32_16x16x32_bf16 v[184:187], v[208:211], v[208:211], v[184:187]
  buffer_load_dwordx4 a[200:203], v3, s[24:27], s20 offen offset:0 sc1
  v_mfma_f32_16x16x32_bf16 v[144:147], a[60:63], v[220:223], v[144:147]
  v_mfma_f32_16x16x32_bf16 v[152:155], a[64:67], v[220:223], v[152:155]
  v_mfma_f32_16x16x32_bf16 v[160:163], a[68:71], v[220:223], v[160:163]
  v_mfma_f32_16x16x32_bf16 v[168:171], a[72:75], v[220:223], v[168:171]
  buffer_load_dwordx4 a[204:207], v3, s[24:27], s20 offen offset:1024 sc1
  v_mfma_f32_16x16x32_bf16 v[176:179], a[76:79], v[220:223], v[176:179]
  ds_read_b128 v[220:223], v133 offset:9216
  v_mfma_f32_16x16x32_bf16 v[140:143], a[60:63], v[216:219], v[140:143]
  v_mfma_f32_16x16x32_bf16 v[148:151], a[64:67], v[216:219], v[148:151]
  v_mfma_f32_16x16x32_bf16 v[156:159], a[68:71], v[216:219], v[156:159]
  buffer_load_dwordx4 a[208:211], v3, s[24:27], s20 offen offset:2048 sc1
  v_mfma_f32_16x16x32_bf16 v[164:167], a[72:75], v[216:219], v[164:167]
  v_mfma_f32_16x16x32_bf16 v[172:175], a[76:79], v[216:219], v[172:175]
  v_mfma_f32_16x16x32_bf16 v[180:183], v[188:191], v[216:219], v[180:183]
  v_mfma_f32_16x16x32_bf16 v[184:187], v[216:219], v[216:219], v[184:187]
  buffer_load_dwordx4 a[212:215], v3, s[24:27], s20 offen offset:3072 sc1
  s_add_u32 s20, s17, 65536
  s_waitcnt lgkmcnt(7)
  v_mfma_f32_16x16x32_bf16 v[144:147], a[80:83], v[228:231], v[144:147]
  v_mfma_f32_16x16x32_bf16 v[152:155], a[84:87], v[228:231], v[152:155]
  v_mfma_f32_16x16x32_bf16 v[160:163], a[88:91], v[228:231], v[160:163]
  s_waitcnt lgkmcnt(6)
  v_mfma_f32_16x16x32_bf16 v[184:187], v[224:227], v[224:227], v[184:187]
  buffer_load_dwordx4 a[216:219], v3, s[24:27], s20 offen offset:0 sc1
  s_add_u32 s20, s17, 81920
  v_mfma_f32_16x16x32_bf16 v[168:171], a[92:95], v[228:231], v[168:171]
  v_mfma_f32_16x16x32_bf16 v[180:183], v[188:191], v[224:227], v[180:183]
  v_mfma_f32_16x16x32_bf16 v[176:179], a[96:99], v[228:231], v[176:179]
  s_waitcnt lgkmcnt(5)
  v_mfma_f32_16x16x32_bf16 v[144:147], a[100:103], v[236:239], v[144:147]
  buffer_load_dwordx4 a[220:223], v3, s[24:27], s20 offen offset:0 sc1
  v_mfma_f32_16x16x32_bf16 v[152:155], a[104:107], v[236:239], v[152:155]
  v_mfma_f32_16x16x32_bf16 v[160:163], a[108:111], v[236:239], v[160:163]
  s_waitcnt lgkmcnt(4)
  v_mfma_f32_16x16x32_bf16 v[184:187], v[232:235], v[232:235], v[184:187]
  v_mfma_f32_16x16x32_bf16 v[168:171], a[112:115], v[236:239], v[168:171]
  buffer_load_dwordx4 a[224:227], v3, s[24:27], s20 offen offset:1024 sc1
  v_mfma_f32_16x16x32_bf16 v[180:183], v[188:191], v[232:235], v[180:183]
  v_mfma_f32_16x16x32_bf16 v[176:179], a[116:119], v[236:239], v[176:179]
  s_waitcnt lgkmcnt(3)
  v_mfma_f32_16x16x32_bf16 v[144:147], a[120:123], v[196:199], v[144:147]
  v_mfma_f32_16x16x32_bf16 v[152:155], a[124:127], v[196:199], v[152:155]
  buffer_load_dwordx4 a[228:231], v3, s[24:27], s20 offen offset:2048 sc1
  v_mfma_f32_16x16x32_bf16 v[160:163], a[128:131], v[196:199], v[160:163]
  v_mfma_f32_16x16x32_bf16 v[168:171], a[132:135], v[196:199], v[168:171]
  v_mfma_f32_16x16x32_bf16 v[176:179], a[136:139], v[196:199], v[176:179]
  s_waitcnt lgkmcnt(2)
  v_mfma_f32_16x16x32_bf16 v[144:147], a[140:143], v[204:207], v[144:147]
  buffer_load_dwordx4 a[232:235], v3, s[24:27], s20 offen offset:3072 sc1
  s_add_u32 s20, s17, 86016
  v_mfma_f32_16x16x32_bf16 v[140:143], a[80:83], v[224:227], v[140:143]
  v_mfma_f32_16x16x32_bf16 v[148:151], a[84:87], v[224:227], v[148:151]
  v_mfma_f32_16x16x32_bf16 v[156:159], a[88:91], v[224:227], v[156:159]
  v_mfma_f32_16x16x32_bf16 v[164:167], a[92:95], v[224:227], v[164:167]
  buffer_load_dwordx4 a[236:239], v3, s[24:27], s20 offen offset:0 sc1
  v_mfma_f32_16x16x32_bf16 v[172:175], a[96:99], v[224:227], v[172:175]
  v_mfma_f32_16x16x32_bf16 v[152:155], a[144:147], v[204:207], v[152:155]
  v_mfma_f32_16x16x32_bf16 v[160:163], a[148:151], v[204:207], v[160:163]
  v_mfma_f32_16x16x32_bf16 v[168:171], a[152:155], v[204:207], v[168:171]
  buffer_store_dwordx4 v[192:195], v240, s[24:27], s47 offen offset:0 sc1
  v_mfma_f32_16x16x32_bf16 v[176:179], a[156:159], v[204:207], v[176:179]
  s_nop 0
  ds_read_b128 v[192:195], v130 offset:6144
  s_waitcnt lgkmcnt(2)
  v_mfma_f32_16x16x32_bf16 v[144:147], a[160:163], v[212:215], v[144:147]
  v_mfma_f32_16x16x32_bf16 v[140:143], a[100:103], v[232:235], v[140:143]
  v_mfma_f32_16x16x32_bf16 v[148:151], a[104:107], v[232:235], v[148:151]
  buffer_store_dwordx4 v[200:203], v240, s[24:27], s47 offen offset:1024 sc1
  v_mfma_f32_16x16x32_bf16 v[156:159], a[108:111], v[232:235], v[156:159]
  s_nop 0
  ds_read_b128 v[200:203], v131 offset:7168
  v_mfma_f32_16x16x32_bf16 v[164:167], a[112:115], v[232:235], v[164:167]
  v_mfma_f32_16x16x32_bf16 v[172:175], a[116:119], v[232:235], v[172:175]
  v_mfma_f32_16x16x32_bf16 v[152:155], a[164:167], v[212:215], v[152:155]
  buffer_store_dwordx4 v[208:211], v240, s[24:27], s47 offen offset:2048 sc1
  v_mfma_f32_16x16x32_bf16 v[160:163], a[168:171], v[212:215], v[160:163]
  s_nop 0
  ds_read_b128 v[208:211], v124 offset:8192
  s_waitcnt lgkmcnt(2)
  v_mfma_f32_16x16x32_bf16 v[184:187], v[192:195], v[192:195], v[184:187]
  v_mfma_f32_16x16x32_bf16 v[180:183], v[188:191], v[192:195], v[180:183]
  v_mfma_f32_16x16x32_bf16 v[168:171], a[172:175], v[212:215], v[168:171]
  buffer_store_dwordx4 v[216:219], v240, s[24:27], s47 offen offset:3072 sc1
  s_add_u32 s47, s47, 4096
  v_mfma_f32_16x16x32_bf16 v[176:179], a[176:179], v[212:215], v[176:179]
  ds_read_b128 v[216:219], v125 offset:9216
  s_waitcnt lgkmcnt(2)
  v_mfma_f32_16x16x32_bf16 v[184:187], v[200:203], v[200:203], v[184:187]
  v_mfma_f32_16x16x32_bf16 v[180:183], v[188:191], v[200:203], v[180:183]
  s_waitcnt vmcnt(34)
  v_mfma_f32_16x16x32_bf16 v[144:147], a[180:183], v[220:223], v[144:147]
  buffer_store_dwordx4 v[224:227], v240, s[24:27], s47 offen offset:0 sc1
  v_mfma_f32_16x16x32_bf16 v[140:143], a[120:123], v[192:195], v[140:143]
  s_waitcnt lgkmcnt(1)
  v_mfma_f32_16x16x32_bf16 v[184:187], v[208:211], v[208:211], v[184:187]
  s_nop 3
  ds_write_b128 v241, v[144:147] offset:0
  v_mfma_f32_16x16x32_bf16 v[180:183], v[188:191], v[208:211], v[180:183]
  v_mfma_f32_16x16x32_bf16 v[148:151], a[124:127], v[192:195], v[148:151]
  buffer_store_dwordx4 v[232:235], v240, s[24:27], s47 offen offset:1024 sc1
  v_mfma_f32_16x16x32_bf16 v[156:159], a[128:131], v[192:195], v[156:159]
  v_mfma_f32_16x16x32_bf16 v[164:167], a[132:135], v[192:195], v[164:167]
  v_mfma_f32_16x16x32_bf16 v[172:175], a[136:139], v[192:195], v[172:175]
  s_waitcnt vmcnt(35)
  v_mfma_f32_16x16x32_bf16 v[152:155], a[184:187], v[220:223], v[152:155]
  buffer_store_dwordx4 v[192:195], v240, s[24:27], s47 offen offset:2048 sc1
  s_waitcnt vmcnt(35)
  v_mfma_f32_16x16x32_bf16 v[160:163], a[188:191], v[220:223], v[160:163]
  s_waitcnt lgkmcnt(1)
  v_mfma_f32_16x16x32_bf16 v[184:187], v[216:219], v[216:219], v[184:187]
  s_nop 2
  ds_write_b128 v241, v[152:155] offset:1024
  s_waitcnt vmcnt(34)
  v_mfma_f32_16x16x32_bf16 v[168:171], a[192:195], v[220:223], v[168:171]
  v_mfma_f32_16x16x32_bf16 v[180:183], v[188:191], v[216:219], v[180:183]
  buffer_store_dwordx4 v[200:203], v240, s[24:27], s47 offen offset:3072 sc1
  s_add_u32 s47, s47, 4096
  s_waitcnt vmcnt(34)
  v_mfma_f32_16x16x32_bf16 v[176:179], a[196:199], v[220:223], v[176:179]
  s_xor_b32 s33, s3, 2
  s_mul_i32 s33, s33, 5120
  v_mfma_f32_16x16x32_bf16 v[140:143], a[140:143], v[200:203], v[140:143]
  v_add_u32 v242, s33, v3
  s_lshl_b32 s33, s3, 7
  v_mfma_f32_16x16x32_bf16 v[148:151], a[144:147], v[200:203], v[148:151]
  ds_write_b128 v241, v[160:163] offset:2048
  v_lshl_add_u32 v243, v1, 3, s33
  v_mfma_f32_16x16x32_bf16 v[156:159], a[148:151], v[200:203], v[156:159]
  buffer_store_dwordx4 v[208:211], v240, s[24:27], s47 offen offset:0 sc1
  v_cndmask_b32 v184, v184, v185, s[60:61]
  v_mfma_f32_16x16x32_bf16 v[164:167], a[152:155], v[200:203], v[164:167]
  v_cndmask_b32 v186, v186, v187, s[60:61]
  v_xor_b32 v244, 0x180, v243
  v_mfma_f32_16x16x32_bf16 v[172:175], a[156:159], v[200:203], v[172:175]
  v_cndmask_b32 v181, v184, v186, s[62:63]
  ds_write_b128 v241, v[168:171] offset:3072
  v_mfma_f32_16x16x32_bf16 v[140:143], a[160:163], v[208:211], v[140:143]
  v_mfma_f32_16x16x32_bf16 v[148:151], a[164:167], v[208:211], v[148:151]
  buffer_store_dwordx4 v[216:219], v240, s[24:27], s47 offen offset:1024 sc1
  v_mfma_f32_16x16x32_bf16 v[156:159], a[168:171], v[208:211], v[156:159]
  v_mfma_f32_16x16x32_bf16 v[164:167], a[172:175], v[208:211], v[164:167]
  ds_write_b128 v241, v[176:179] offset:4096
  v_mfma_f32_16x16x32_bf16 v[172:175], a[176:179], v[208:211], v[172:175]
  v_mfma_f32_16x16x32_bf16 v[140:143], a[180:183], v[216:219], v[140:143]
  v_mfma_f32_16x16x32_bf16 v[148:151], a[184:187], v[216:219], v[148:151]
  v_mfma_f32_16x16x32_bf16 v[156:159], a[188:191], v[216:219], v[156:159]
  v_mfma_f32_16x16x32_bf16 v[164:167], a[192:195], v[216:219], v[164:167]
  v_mfma_f32_16x16x32_bf16 v[172:175], a[196:199], v[216:219], v[172:175]
  s_waitcnt vmcnt(30)
  v_cmp_gt_u32 vcc, 4, v11
  s_nop 4
  s_cbranch_vccz CHK6_OUT
  s_mov_b64 exec, 0xffff
  s_movk_i32 s22, 0x7fff
CHK6:
  v_mov_b32 v11, 0
  buffer_atomic_add v11, v10, s[24:27], s12 offen sc0 sc1
  s_waitcnt vmcnt(0)
  v_cmp_gt_u32 vcc, 4, v11
  s_sub_u32 s22, s22, 1
  s_cbranch_scc1 CHK6_END
  s_cbranch_vccnz CHK6
CHK6_END:
  s_mov_b64 exec, -1
CHK6_OUT:
  s_nop 4
  s_mov_b64 exec, s[64:65]
  ds_write_b64 v243, v[180:181] offset:20480
  s_mov_b64 exec, -1
  s_waitcnt lgkmcnt(0)
  s_barrier
  s_add_u32 m0, s19, 40960
  s_add_u32 s20, s16, 81920
  buffer_load_dwordx4 v3, s[24:27], s20 offen offset:0 sc1 lds
  ds_read_b64 v[180:181], v243 offset:20480
  ds_read_b64 v[182:183], v244 offset:20480
  ds_read_b128 v[144:147], v242 offset:0
  ds_read_b128 v[152:155], v242 offset:1024
  ds_read_b128 v[176:179], v242 offset:4096
  ds_read_b128 v[160:163], v242 offset:2048
  ds_read_b128 v[168:171], v242 offset:3072
  v_mov_b32 v246, 0xc0135761
  v_mov_b32 v247, 0xc0135761
  s_mov_b32 s66, 0xbdd2d3e8
  s_mov_b32 s67, 0xbdd2d3e8
  v_lshlrev_b32 v7, 3, v1
  v_lshl_add_u32 v7, v2, 30, v7
  v_add_u32 v241, s56, v3
  v_add_u32 v240, s57, v3
  buffer_load_dwordx4 v3, s[24:27], s20 offen offset:1024 sc1 lds
  v_add_u32 v6, s56, v8
  buffer_load_dwordx4 v3, s[24:27], s20 offen offset:2048 sc1 lds
  s_waitcnt lgkmcnt(5)
  v_pk_add_f32 v[180:181], v[180:181], v[182:183]
  v_mul_f32 v252, 0x3acccccd, v180
  v_mul_f32 v4, 0x3acccccd, v181
  v_fma_f32 v4, -v252, v252, v4
  v_max_f32 v4, 0, v4
  v_add_f32 v5, 0x3727c5ac, v4
  v_rsq_f32 v253, v5
  s_nop 0
  v_mul_f32 v4, v4, v253
  v_fmaak_f32 v4, v4, v253, 0x3727c5ac
  v_rsq_f32 v4, v4
  s_nop 0
  v_mul_f32 v248, v4, v253
  buffer_load_dwordx4 v3, s[24:27], s20 offen offset:3072 sc1 lds
  s_add_u32 m0, s19, 45056
  s_add_u32 s20, s16, 86016
  s_waitcnt lgkmcnt(4)
  v_pk_add_f32 v[140:141], v[140:141], v[144:145]
  v_pk_add_f32 v[142:143], v[142:143], v[146:147]
  s_waitcnt lgkmcnt(3)
  v_pk_add_f32 v[148:149], v[148:149], v[152:153]
  v_pk_add_f32 v[150:151], v[150:151], v[154:155]
  s_waitcnt lgkmcnt(2)
  v_pk_add_f32 v[172:173], v[172:173], v[176:177]
  v_pk_add_f32 v[174:175], v[174:175], v[178:179]
  s_waitcnt lgkmcnt(1)
  v_pk_add_f32 v[156:157], v[156:157], v[160:161]
  v_pk_add_f32 v[158:159], v[158:159], v[162:163]
  s_waitcnt lgkmcnt(0)
  v_pk_add_f32 v[164:165], v[164:165], v[168:169]
  v_pk_add_f32 v[166:167], v[166:167], v[170:171]
  buffer_load_dwordx4 v3, s[24:27], s20 offen sc1 lds
  s_add_u32 m0, s19, 61440
  s_add_u32 s20, s17, 0
  buffer_load_dwordx4 v3, s[24:27], s20 offen offset:0 sc1 lds
  buffer_load_dwordx4 v3, s[24:27], s20 offen offset:1024 sc1 lds
  buffer_load_dwordx4 v3, s[24:27], s20 offen offset:2048 sc1 lds
  buffer_load_dwordx4 v3, s[24:27], s20 offen offset:3072 sc1 lds
  s_add_u32 m0, s19, 65536
  s_add_u32 s20, s17, 4096
  s_lshl_b32 s33, s45, 4
  s_sub_u32 s33, s33, s37
  v_add_u32 v5, s33, v1
  s_mul_i32 s33, s29, 5120
  s_add_u32 s46, s46, s33
  s_add_u32 s46, s46, s68
  s_mul_i32 s33, s30, 3072
  s_add_u32 s48, s46, s33
  s_lshl_b32 s33, s30, 9
  s_add_u32 s49, s46, s33
  s_lshl_b32 s45, s45, 7
  s_lshl_b32 s33, s29, 14
  s_add_u32 s44, s45, s33
  buffer_load_dwordx4 v3, s[24:27], s20 offen sc1 lds
  s_add_u32 s44, s44, 37224448
  v_cmp_gt_u32 vcc, 2048, v5
  s_nop 1
  v_cndmask_b32 v248, 0, v248, vcc
  v_mul_f32 v250, v248, v252
  s_waitcnt vmcnt(39)
  v_pk_mul_f32 v[68:69], v[68:69], v[250:251] op_sel_hi:[1,0]
  v_pk_mul_f32 v[70:71], v[70:71], v[250:251] op_sel_hi:[1,0]
  s_waitcnt vmcnt(38)
  v_pk_mul_f32 v[72:73], v[72:73], v[250:251] op_sel_hi:[1,0]
  v_pk_mul_f32 v[74:75], v[74:75], v[250:251] op_sel_hi:[1,0]
  s_waitcnt vmcnt(35)
  v_pk_mul_f32 v[84:85], v[84:85], v[250:251] op_sel_hi:[1,0]
  v_pk_mul_f32 v[86:87], v[86:87], v[250:251] op_sel_hi:[1,0]
  v_pk_fma_f32 v[140:141], v[140:141], v[248:249], v[68:69] op_sel_hi:[1,0,1] neg_lo:[0,0,1] neg_hi:[0,0,1]
  v_pk_fma_f32 v[142:143], v[142:143], v[248:249], v[70:71] op_sel_hi:[1,0,1] neg_lo:[0,0,1] neg_hi:[0,0,1]
  buffer_store_dwordx2 v[252:253], v7, s[24:27], s44 offen sc1
  v_pk_fma_f32 v[148:149], v[148:149], v[248:249], v[72:73] op_sel_hi:[1,0,1] neg_lo:[0,0,1] neg_hi:[0,0,1]
  v_pk_fma_f32 v[150:151], v[150:151], v[248:249], v[74:75] op_sel_hi:[1,0,1] neg_lo:[0,0,1] neg_hi:[0,0,1]
  v_pk_mul_f32 v[76:77], v[76:77], v[250:251] op_sel_hi:[1,0]
  v_pk_mul_f32 v[78:79], v[78:79], v[250:251] op_sel_hi:[1,0]
  v_pk_mul_f32 v[80:81], v[80:81], v[250:251] op_sel_hi:[1,0]
  v_pk_mul_f32 v[82:83], v[82:83], v[250:251] op_sel_hi:[1,0]
  v_pk_fma_f32 v[172:173], v[172:173], v[248:249], v[84:85] op_sel_hi:[1,0,1] neg_lo:[0,0,1] neg_hi:[0,0,1]
  v_pk_fma_f32 v[174:175], v[174:175], v[248:249], v[86:87] op_sel_hi:[1,0,1] neg_lo:[0,0,1] neg_hi:[0,0,1]
  v_pk_mul_f32 v[192:193], v[140:141], v[140:141]
  v_pk_mul_f32 v[194:195], v[142:143], v[142:143]
  v_pk_mul_f32 v[196:197], v[148:149], v[148:149]
  v_pk_mul_f32 v[198:199], v[150:151], v[150:151]
  v_pk_fma_f32 v[156:157], v[156:157], v[248:249], v[76:77] op_sel_hi:[1,0,1] neg_lo:[0,0,1] neg_hi:[0,0,1]
  v_pk_fma_f32 v[158:159], v[158:159], v[248:249], v[78:79] op_sel_hi:[1,0,1] neg_lo:[0,0,1] neg_hi:[0,0,1]
  v_pk_fma_f32 v[164:165], v[164:165], v[248:249], v[80:81] op_sel_hi:[1,0,1] neg_lo:[0,0,1] neg_hi:[0,0,1]
  v_pk_fma_f32 v[166:167], v[166:167], v[248:249], v[82:83] op_sel_hi:[1,0,1] neg_lo:[0,0,1] neg_hi:[0,0,1]
  v_pk_mul_f32 v[208:209], v[172:173], v[172:173]
  v_pk_mul_f32 v[210:211], v[174:175], v[174:175]
  v_pk_fma_f32 v[192:193], v[192:193], s[66:67], v[246:247]
  v_pk_fma_f32 v[194:195], v[194:195], s[66:67], v[246:247]
  v_pk_fma_f32 v[196:197], v[196:197], s[66:67], v[246:247]
  v_pk_fma_f32 v[198:199], v[198:199], s[66:67], v[246:247]
  v_pk_mul_f32 v[200:201], v[156:157], v[156:157]
  v_pk_mul_f32 v[202:203], v[158:159], v[158:159]
  v_pk_mul_f32 v[204:205], v[164:165], v[164:165]
  v_pk_mul_f32 v[206:207], v[166:167], v[166:167]
  v_pk_fma_f32 v[208:209], v[208:209], s[66:67], v[246:247]
  v_pk_fma_f32 v[210:211], v[210:211], s[66:67], v[246:247]
  v_pk_mul_f32 v[192:193], v[192:193], v[140:141]
  v_pk_mul_f32 v[194:195], v[194:195], v[142:143]
  v_pk_mul_f32 v[196:197], v[196:197], v[148:149]
  v_pk_mul_f32 v[198:199], v[198:199], v[150:151]
  v_pk_fma_f32 v[200:201], v[200:201], s[66:67], v[246:247]
  v_pk_fma_f32 v[202:203], v[202:203], s[66:67], v[246:247]
  v_pk_fma_f32 v[204:205], v[204:205], s[66:67], v[246:247]
  v_pk_fma_f32 v[206:207], v[206:207], s[66:67], v[246:247]
  v_pk_mul_f32 v[208:209], v[208:209], v[172:173]
  v_pk_mul_f32 v[210:211], v[210:211], v[174:175]
  v_exp_f32 v192, v192
  v_exp_f32 v193, v193
  v_exp_f32 v194, v194
  v_exp_f32 v195, v195
  v_exp_f32 v196, v196
  v_exp_f32 v197, v197
  v_exp_f32 v198, v198
  v_exp_f32 v199, v199
  v_pk_mul_f32 v[200:201], v[200:201], v[156:157]
  v_pk_mul_f32 v[202:203], v[202:203], v[158:159]
  v_pk_mul_f32 v[204:205], v[204:205], v[164:165]
  v_pk_mul_f32 v[206:207], v[206:207], v[166:167]
  v_exp_f32 v208, v208
  v_exp_f32 v209, v209
  v_exp_f32 v210, v210
  v_exp_f32 v211, v211
  v_pk_add_f32 v[192:193], v[192:193], 1.0 op_sel_hi:[1,0]
  v_pk_add_f32 v[194:195], v[194:195], 1.0 op_sel_hi:[1,0]
  v_pk_add_f32 v[196:197], v[196:197], 1.0 op_sel_hi:[1,0]
  v_pk_add_f32 v[198:199], v[198:199], 1.0 op_sel_hi:[1,0]
  v_exp_f32 v200, v200
  v_exp_f32 v201, v201
  v_exp_f32 v202, v202
  v_exp_f32 v203, v203
  v_exp_f32 v204, v204
  v_exp_f32 v205, v205
  v_exp_f32 v206, v206
  v_exp_f32 v207, v207
  v_pk_add_f32 v[208:209], v[208:209], 1.0 op_sel_hi:[1,0]
  v_pk_add_f32 v[210:211], v[210:211], 1.0 op_sel_hi:[1,0]
  v_rcp_f32 v192, v192
  v_rcp_f32 v193, v193
  v_rcp_f32 v194, v194
  v_rcp_f32 v195, v195
  v_rcp_f32 v196, v196
  v_rcp_f32 v197, v197
  v_rcp_f32 v198, v198
  v_rcp_f32 v199, v199
  v_pk_add_f32 v[200:201], v[200:201], 1.0 op_sel_hi:[1,0]
  v_pk_add_f32 v[202:203], v[202:203], 1.0 op_sel_hi:[1,0]
  v_pk_add_f32 v[204:205], v[204:205], 1.0 op_sel_hi:[1,0]
  v_pk_add_f32 v[206:207], v[206:207], 1.0 op_sel_hi:[1,0]
  v_rcp_f32 v208, v208
  v_rcp_f32 v209, v209
  v_rcp_f32 v210, v210
  v_rcp_f32 v211, v211
  v_pk_mul_f32 v[140:141], v[140:141], v[192:193]
  v_pk_mul_f32 v[142:143], v[142:143], v[194:195]
  v_pk_mul_f32 v[148:149], v[148:149], v[196:197]
  v_pk_mul_f32 v[150:151], v[150:151], v[198:199]
  v_rcp_f32 v200, v200
  v_rcp_f32 v201, v201
  v_rcp_f32 v202, v202
  v_rcp_f32 v203, v203
  v_rcp_f32 v204, v204
  v_rcp_f32 v205, v205
  v_rcp_f32 v206, v206
  v_rcp_f32 v207, v207
  v_pk_mul_f32 v[172:173], v[172:173], v[208:209]
  v_pk_mul_f32 v[174:175], v[174:175], v[210:211]
  v_cvt_pk_bf16_f32 v224, v140, v148
  v_cvt_pk_bf16_f32 v225, v141, v149
  v_cvt_pk_bf16_f32 v226, v142, v150
  v_cvt_pk_bf16_f32 v227, v143, v151
  buffer_store_dwordx4 v[224:227], v241, s[24:27], s48 offen offset:0
  v_pk_mul_f32 v[156:157], v[156:157], v[200:201]
  v_pk_mul_f32 v[158:159], v[158:159], v[202:203]
  v_pk_mul_f32 v[164:165], v[164:165], v[204:205]
  v_pk_mul_f32 v[166:167], v[166:167], v[206:207]
  v_cvt_pk_bf16_f32 v232, v172, v173
  v_cvt_pk_bf16_f32 v234, v172, v173
  v_cvt_pk_bf16_f32 v233, v174, v175
  v_cvt_pk_bf16_f32 v235, v174, v175
  v_cvt_pk_bf16_f32 v228, v156, v164
  v_cvt_pk_bf16_f32 v229, v157, v165
  v_cvt_pk_bf16_f32 v230, v158, v166
  v_cvt_pk_bf16_f32 v231, v159, v167
  v_add_u32 v7, s57, v8
  v_permlane16_swap_b32 v232, v234
  buffer_store_dwordx4 v[224:227], v240, s[24:27], s48 offen offset:0 sc1
  v_permlane16_swap_b32 v233, v235
  buffer_store_dwordx4 v[228:231], v241, s[24:27], s48 offen offset:1024
  buffer_store_dwordx4 v[228:231], v240, s[24:27], s48 offen offset:1024 sc1
  s_mov_b64 exec, s[54:55]
  buffer_store_dwordx4 v[232:235], v6, s[24:27], s49 offen offset:2048
  buffer_store_dwordx4 v[232:235], v7, s[24:27], s49 offen offset:2048 sc1
  s_mov_b64 exec, -1
  s_lshl_b32 s28, s9, 4
  s_lshr_b32 s33, s8, 3
  s_lshl_b32 s33, s33, 2
  s_add_u32 s28, s28, s33
  s_add_u32 s28, s28, s3
  s_and_b32 s29, s8, 7
  s_lshr_b32 s30, s29, 1
  s_and_b32 s31, s29, 1
  s_mul_i32 s40, s28, 20480
  s_mul_i32 s33, s30, 5120
  s_add_u32 s40, s40, s33
  s_mul_i32 s33, s31, 3072
  s_add_u32 s41, s40, s33
  s_lshl_b32 s33, s31, 9
  s_add_u32 s42, s40, s33
  s_add_u32 s42, s42, 2048
  s_lshr_b32 s35, s8, 4
  s_lshr_b32 s37, s29, 2
  s_add_u32 s33, s37, 1
  s_sub_u32 s34, 0, s33
  s_cmp_eq_u32 s35, 1
  s_cselect_b32 s33, s34, s33
  s_lshl_b32 s34, s28, 4
  s_add_u32 s33, s33, s34
  v_add_u32 v4, s33, v1
  s_lshl_b32 s37, s37, 1
  v_bfe_u32 v40, v4, 7, 1
  s_add_u32 s37, s37, s35
  v_xor_b32 v40, s35, v40
  s_lshl_b32 s37, s37, 14
  s_add_u32 s35, s37, 37224448
  s_mul_i32 s37, s28, 20480
  s_add_u32 s36, s37, s68
  s_sub_u32 s37, 10506240, s37
  s_lshl_b32 s34, s28, 7
  s_lshl_b32 s14, s9, 9
  s_add_u32 s14, s14, 37048832
  s_lshl_b32 s15, s8, 2
  s_add_u32 s15, s15, s3
  v_lshlrev_b32 v41, 3, v4
  v_lshrrev_b32 v5, 4, v4
  s_lshl_b32 s15, s15, 2
  v_and_b32 v4, 15, v4
  s_add_u32 s15, s15, s14
  v_mul_u32_u24 v5, 61440, v5
  v_mul_u32_u24 v40, 20480, v40
  v_lshlrev_b32 v4, 4, v4
  s_and_b32 s33, s28, 14
  v_add3_u32 v4, v4, v5, v40
  s_lshl_b32 s33, s33, 5
  v_lshl_add_u32 v40, v2, 8, v4
  v_lshrrev_b32 v5, 1, v2
  s_add_u32 s14, s14, s33
  v_lshl_add_u32 v4, v5, 8, v4
  s_and_b32 s33, s8, 16
  v_and_b32 v5, 1, v2
  v_lshrrev_b32 v45, 2, v3
  s_lshl_b32 s33, s33, 2
  v_lshl_add_u32 v44, v5, 3, v4
  v_and_b32 v45, 0x7c, v45
  v_lshlrev_b32 v10, 2, v1
  s_mov_b32 s23, 37036544
  s_sub_u32 s14, s14, s33
  s_getpc_b64 s[4:5]
PF4:
  v_lshlrev_b32 v4, 7, v0
  v_min_u32 v4, C_P6-PF4, v4
  global_load_dword a242, v4, s[4:5]
  s_waitcnt vmcnt(1)
  s_nop 4
  s_movk_i32 s22, 0x7fff
  s_cmp_lg_u32 s56, 0
  s_cbranch_scc1 KM_P4_FAR
  buffer_store_dword v9, v12, s[24:27], s15 offen
  s_barrier
KM_P4_L:
  buffer_load_dword v7, v45, s[24:27], s14 offen sc1
  s_waitcnt vmcnt(0)
  v_cmp_gt_u32 vcc, 1, v7
  s_sub_u32 s22, s22, 1
  s_cbranch_scc1 KM_P4_OUT
  s_cbranch_vccnz KM_P4_L
  s_branch KM_P4_OUT
KM_P4_FAR:
  s_barrier
  s_cmp_lg_u32 s3, 0
  s_cbranch_scc1 KM_P4_END
  s_mov_b64 exec, 1
  buffer_atomic_add v9, v12, s[24:27], s10 offen sc1
  s_mov_b64 exec, 15
KM_P4:
  v_mov_b32 v7, 0
  buffer_atomic_add v7, v13, s[24:27], s23 offen sc0 sc1
  s_waitcnt vmcnt(0)
  v_cmp_gt_u32 vcc, 4, v7
  s_sub_u32 s22, s22, 1
  s_cbranch_scc1 KM_P4_END
  s_cbranch_vccnz KM_P4
KM_P4_END:
  s_mov_b64 exec, -1
  s_barrier
KM_P4_OUT:
  s_nop 4
  buffer_load_dwordx4 a[0:3], v3, s[24:27], s36 offen offset:0 sc1
  ds_read_b128 v[96:99], v15 offset:16384
  ds_read_b128 v[100:103], v15 offset:17408
  ds_read_b128 v[104:107], v15 offset:18432
  ds_read_b128 v[108:111], v15 offset:19456
  ds_read_b128 v[112:115], v15 offset:20480
  ds_read_b128 v[116:119], v15 offset:21504
  ds_read_b128 v[120:123], v15 offset:22528
  ds_read_b128 v[124:127], v15 offset:23552
  ds_read_b128 v[128:131], v15 offset:24576
  ds_read_b128 v[132:135], v15 offset:25600
  ds_read_b128 v[136:139], v15 offset:26624
  ds_read_b128 v[140:143], v15 offset:27648
  ds_read_b128 v[144:147], v15 offset:28672
  ds_read_b128 v[148:151], v15 offset:29696
  ds_read_b128 v[152:155], v15 offset:30720
  buffer_load_dwordx4 a[4:7], v3, s[24:27], s36 offen offset:1024 sc1
  ds_read_b128 v[156:159], v15 offset:31744
  v_mov_b32 v4, 0
  v_mov_b32 v5, 0
  v_mov_b32 v224, 0
  v_mov_b32 v225, 0
  s_mov_b32 s38, 0x3f803f80
  v_lshrrev_b32 v6, 2, v3
  buffer_load_dwordx4 a[8:11], v3, s[24:27], s36 offen offset:2048 sc1
  buffer_load_dwordx4 a[12:15], v3, s[24:27], s36 offen offset:3072 sc1
  s_add_u32 s36, s36, 4096
  buffer_load_dwordx4 a[16:19], v3, s[24:27], s36 offen offset:0 sc1
  buffer_load_dwordx4 a[20:23], v3, s[24:27], s36 offen offset:1024 sc1
  buffer_load_dwordx4 a[24:27], v3, s[24:27], s36 offen offset:2048 sc1
  buffer_load_dwordx4 a[28:31], v3, s[24:27], s36 offen offset:3072 sc1
  s_add_u32 s36, s36, 4096
  buffer_load_dwordx4 a[32:35], v3, s[24:27], s36 offen offset:0 sc1
  buffer_load_dwordx4 a[36:39], v3, s[24:27], s36 offen offset:1024 sc1
  buffer_load_dwordx4 a[40:43], v3, s[24:27], s36 offen offset:2048 sc1
  buffer_load_dwordx4 a[44:47], v3, s[24:27], s36 offen offset:3072 sc1
  s_add_u32 s36, s36, 4096
  s_add_u32 s32, s41, s37
  s_add_u32 s33, s42, s37
  buffer_load_dwordx2 v[208:209], v41, s[24:27], s35 offen sc1
  buffer_load_dwordx4 v[160:163], v40, s[24:27], s32 offen sc1
  buffer_load_dwordx4 v[164:167], v40, s[24:27], s32 offen offset:1024 sc1
  buffer_load_dwordx2 v[168:169], v44, s[24:27], s33 offen sc1
  buffer_load_dwordx4 a[48:51], v3, s[24:27], s36 offen offset:0 sc1
  s_waitcnt vmcnt(16) lgkmcnt(12)
  v_mfma_f32_16x16x32_bf16 v[48:51], v[96:99], a[0:3], 0
  ds_read_b128 v[96:99], v15 offset:32768
  v_mfma_f32_16x16x32_bf16 v[52:55], v[100:103], a[0:3], 0
  buffer_load_dwordx4 a[52:55], v3, s[24:27], s36 offen offset:1024 sc1
  ds_read_b128 v[100:103], v15 offset:33792
  v_mfma_f32_16x16x32_bf16 v[56:59], v[104:107], a[0:3], 0
  ds_read_b128 v[104:107], v15 offset:34816
  v_mfma_f32_16x16x32_bf16 v[60:63], v[108:111], a[0:3], 0
  ds_read_b128 v[108:111], v15 offset:35840
  s_waitcnt lgkmcnt(12)
  v_mfma_f32_16x16x32_bf16 v[64:67], v[112:115], a[0:3], 0
  ds_read_b128 v[112:115], v15 offset:36864
  s_waitcnt vmcnt(16)
  v_mfma_f32_16x16x32_bf16 v[48:51], v[116:119], a[4:7], v[48:51]
  buffer_load_dwordx4 a[56:59], v3, s[24:27], s36 offen offset:2048 sc1
  ds_read_b128 v[116:119], v15 offset:37888
  v_mfma_f32_16x16x32_bf16 v[52:55], v[120:123], a[4:7], v[52:55]
  ds_read_b128 v[120:123], v15 offset:38912
  v_mfma_f32_16x16x32_bf16 v[56:59], v[124:127], a[4:7], v[56:59]
  ds_read_b128 v[124:127], v15 offset:39936
  s_waitcnt lgkmcnt(12)
  v_mfma_f32_16x16x32_bf16 v[60:63], v[128:131], a[4:7], v[60:63]
  ds_read_b128 v[128:131], v15 offset:40960
  v_mfma_f32_16x16x32_bf16 v[64:67], v[132:135], a[4:7], v[64:67]
  buffer_load_dwordx4 a[60:63], v3, s[24:27], s36 offen offset:3072 sc1
  s_add_u32 s36, s36, 4096
  s_waitcnt vmcnt(17)
  v_mfma_f32_16x16x32_bf16 v[48:51], v[136:139], a[8:11], v[48:51]
  ds_read_b128 v[132:135], v15 offset:41984
  ds_read_b128 v[136:139], v15 offset:43008
  v_mfma_f32_16x16x32_bf16 v[52:55], v[140:143], a[8:11], v[52:55]
  ds_read_b128 v[140:143], v15 offset:44032
  s_waitcnt lgkmcnt(12)
  v_mfma_f32_16x16x32_bf16 v[56:59], v[144:147], a[8:11], v[56:59]
  ds_read_b128 v[144:147], v15 offset:45056
  v_mfma_f32_16x16x32_bf16 v[60:63], v[148:151], a[8:11], v[60:63]
  buffer_load_dwordx4 a[64:67], v3, s[24:27], s36 offen offset:0 sc1
  ds_read_b128 v[148:151], v15 offset:46080
  v_mfma_f32_16x16x32_bf16 v[64:67], v[152:155], a[8:11], v[64:67]
  ds_read_b128 v[152:155], v15 offset:47104
  s_waitcnt vmcnt(17)
  v_mfma_f32_16x16x32_bf16 v[48:51], v[156:159], a[12:15], v[48:51]
  ds_read_b128 v[156:159], v15 offset:48128
  s_waitcnt lgkmcnt(12)
  v_mfma_f32_16x16x32_bf16 v[52:55], v[96:99], a[12:15], v[52:55]
  ds_read_b128 v[96:99], v15 offset:49152
  v_mfma_f32_16x16x32_bf16 v[56:59], v[100:103], a[12:15], v[56:59]
  buffer_load_dwordx4 a[68:71], v3, s[24:27], s36 offen offset:1024 sc1
  ds_read_b128 v[100:103], v15 offset:50176
  v_mfma_f32_16x16x32_bf16 v[60:63], v[104:107], a[12:15], v[60:63]
  ds_read_b128 v[104:107], v15 offset:51200
  v_mfma_f32_16x16x32_bf16 v[64:67], v[108:111], a[12:15], v[64:67]
  ds_read_b128 v[108:111], v15 offset:52224
  s_waitcnt vmcnt(17) lgkmcnt(12)
  v_mfma_f32_16x16x32_bf16 v[48:51], v[112:115], a[16:19], v[48:51]
  ds_read_b128 v[112:115], v15 offset:53248
  v_mfma_f32_16x16x32_bf16 v[52:55], v[116:119], a[16:19], v[52:55]
  buffer_load_dwordx4 a[72:75], v3, s[24:27], s36 offen offset:2048 sc1
  ds_read_b128 v[116:119], v15 offset:54272
  v_mfma_f32_16x16x32_bf16 v[56:59], v[120:123], a[16:19], v[56:59]
  ds_read_b128 v[120:123], v15 offset:55296
  v_mfma_f32_16x16x32_bf16 v[60:63], v[124:127], a[16:19], v[60:63]
  ds_read_b128 v[124:127], v15 offset:56320
  s_waitcnt lgkmcnt(12)
  v_mfma_f32_16x16x32_bf16 v[64:67], v[128:131], a[16:19], v[64:67]
  ds_read_b128 v[128:131], v15 offset:57344
  s_waitcnt vmcnt(17)
  v_mfma_f32_16x16x32_bf16 v[48:51], v[132:135], a[20:23], v[48:51]
  buffer_load_dwordx4 a[76:79], v3, s[24:27], s36 offen offset:3072 sc1
  s_add_u32 s36, s36, 4096
  s_add_u32 m0, s19, 0
  s_add_u32 s20, s17, 20480
  v_mfma_f32_16x16x32_bf16 v[52:55], v[136:139], a[20:23], v[52:55]
  ds_read_b128 v[132:135], v15 offset:58368
  ds_read_b128 v[136:139], v15 offset:59392
  v_mfma_f32_16x16x32_bf16 v[56:59], v[140:143], a[20:23], v[56:59]
  ds_read_b128 v[140:143], v15 offset:60416
  s_waitcnt lgkmcnt(12)
  v_mfma_f32_16x16x32_bf16 v[60:63], v[144:147], a[20:23], v[60:63]
  ds_read_b128 v[144:147], v15 offset:61440
  buffer_load_dwordx4 v3, s[24:27], s20 offen offset:0 sc1 lds
  v_mfma_f32_16x16x32_bf16 v[64:67], v[148:151], a[20:23], v[64:67]
  ds_read_b128 v[148:151], v15 offset:62464
  s_waitcnt vmcnt(18)
  v_mfma_f32_16x16x32_bf16 v[48:51], v[152:155], a[24:27], v[48:51]
  ds_read_b128 v[152:155], v15 offset:63488
  v_mfma_f32_16x16x32_bf16 v[52:55], v[156:159], a[24:27], v[52:55]
  ds_read_b128 v[156:159], v15 offset:64512
  s_waitcnt lgkmcnt(12)
  v_mfma_f32_16x16x32_bf16 v[56:59], v[96:99], a[24:27], v[56:59]
  ds_read_b128 v[96:99], v16 offset:0
  buffer_load_dwordx4 v3, s[24:27], s20 offen offset:1024 sc1 lds
  v_mfma_f32_16x16x32_bf16 v[60:63], v[100:103], a[24:27], v[60:63]
  ds_read_b128 v[100:103], v16 offset:1024
  v_mfma_f32_16x16x32_bf16 v[64:67], v[104:107], a[24:27], v[64:67]
  ds_read_b128 v[104:107], v16 offset:2048
  s_waitcnt vmcnt(18)
  v_mfma_f32_16x16x32_bf16 v[48:51], v[108:111], a[28:31], v[48:51]
  ds_read_b128 v[108:111], v16 offset:3072
  s_waitcnt lgkmcnt(12)
  v_mfma_f32_16x16x32_bf16 v[52:55], v[112:115], a[28:31], v[52:55]
  ds_read_b128 v[112:115], v16 offset:4096
  buffer_load_dwordx4 v3, s[24:27], s20 offen offset:2048 sc1 lds
  v_mfma_f32_16x16x32_bf16 v[56:59], v[116:119], a[28:31], v[56:59]
  ds_read_b128 v[116:119], v16 offset:5120
  v_mfma_f32_16x16x32_bf16 v[60:63], v[120:123], a[28:31], v[60:63]
  ds_read_b128 v[120:123], v16 offset:6144
  v_mfma_f32_16x16x32_bf16 v[64:67], v[124:127], a[28:31], v[64:67]
  ds_read_b128 v[124:127], v16 offset:7168
  s_waitcnt vmcnt(18) lgkmcnt(12)
  v_mfma_f32_16x16x32_bf16 v[48:51], v[128:131], a[32:35], v[48:51]
  ds_read_b128 v[128:131], v16 offset:8192
  buffer_load_dwordx4 v3, s[24:27], s20 offen offset:3072 sc1 lds
  s_add_u32 m0, s19, 4096
  s_add_u32 s20, s17, 24576
  v_mfma_f32_16x16x32_bf16 v[52:55], v[132:135], a[32:35], v[52:55]
  ds_read_b128 v[132:135], v16 offset:9216
  v_mfma_f32_16x16x32_bf16 v[56:59], v[136:139], a[32:35], v[56:59]
  ds_read_b128 v[136:139], v16 offset:10240
  v_mfma_f32_16x16x32_bf16 v[60:63], v[140:143], a[32:35], v[60:63]
  ds_read_b128 v[140:143], v16 offset:11264
  s_waitcnt lgkmcnt(12)
  v_mfma_f32_16x16x32_bf16 v[64:67], v[144:147], a[32:35], v[64:67]
  buffer_load_dwordx4 v3, s[24:27], s20 offen sc1 lds
  s_add_u32 m0, s19, 20480
  s_add_u32 s20, s17, 40960
  s_waitcnt vmcnt(19)
  v_mfma_f32_16x16x32_bf16 v[48:51], v[148:151], a[36:39], v[48:51]
  ds_read_b128 v[144:147], v16 offset:12288
  ds_read_b128 v[148:151], v16 offset:13312
  v_mfma_f32_16x16x32_bf16 v[52:55], v[152:155], a[36:39], v[52:55]
  ds_read_b128 v[152:155], v16 offset:14336
  s_waitcnt vmcnt(16)
  v_mul_f32 v214, v208, v209
  v_mfma_f32_16x16x32_bf16 v[56:59], v[156:159], a[36:39], v[56:59]
  ds_read_b128 v[156:159], v16 offset:15360
  s_waitcnt lgkmcnt(12)
  v_mfma_f32_16x16x32_bf16 v[60:63], v[96:99], a[36:39], v[60:63]
  buffer_load_dwordx4 v3, s[24:27], s20 offen offset:0 sc1 lds
  ds_read_b128 v[96:99], v16 offset:16384
  v_mfma_f32_16x16x32_bf16 v[64:67], v[100:103], a[36:39], v[64:67]
  ds_read_b128 v[100:103], v16 offset:17408
  s_waitcnt vmcnt(16)
  v_lshlrev_b32 v20, 16, v160
  v_mfma_f32_16x16x32_bf16 v[48:51], v[104:107], a[40:43], v[48:51]
  ds_read_b128 v[104:107], v16 offset:18432
  v_and_b32 v24, 0xffff0000, v160
  v_mfma_f32_16x16x32_bf16 v[52:55], v[108:111], a[40:43], v[52:55]
  ds_read_b128 v[108:111], v16 offset:19456
  v_lshlrev_b32 v21, 16, v161
  s_waitcnt lgkmcnt(12)
  v_mfma_f32_16x16x32_bf16 v[56:59], v[112:115], a[40:43], v[56:59]
  buffer_load_dwordx4 v3, s[24:27], s20 offen offset:1024 sc1 lds
  ds_read_b128 v[112:115], v16 offset:20480
  v_mfma_f32_16x16x32_bf16 v[60:63], v[116:119], a[40:43], v[60:63]
  ds_read_b128 v[116:119], v16 offset:21504
  v_and_b32 v25, 0xffff0000, v161
  v_mfma_f32_16x16x32_bf16 v[64:67], v[120:123], a[40:43], v[64:67]
  ds_read_b128 v[120:123], v16 offset:22528
  v_lshlrev_b32 v22, 16, v162
  v_mfma_f32_16x16x32_bf16 v[48:51], v[124:127], a[44:47], v[48:51]
  ds_read_b128 v[124:127], v16 offset:23552
  v_and_b32 v26, 0xffff0000, v162
  s_waitcnt lgkmcnt(12)
  v_mfma_f32_16x16x32_bf16 v[52:55], v[128:131], a[44:47], v[52:55]
  buffer_load_dwordx4 v3, s[24:27], s20 offen offset:2048 sc1 lds
  ds_read_b128 v[128:131], v16 offset:24576
  v_mfma_f32_16x16x32_bf16 v[56:59], v[132:135], a[44:47], v[56:59]
  ds_read_b128 v[132:135], v16 offset:25600
  v_lshlrev_b32 v23, 16, v163
  v_mfma_f32_16x16x32_bf16 v[60:63], v[136:139], a[44:47], v[60:63]
  ds_read_b128 v[136:139], v16 offset:26624
  v_and_b32 v27, 0xffff0000, v163
  v_mfma_f32_16x16x32_bf16 v[64:67], v[140:143], a[44:47], v[64:67]
  ds_read_b128 v[140:143], v16 offset:27648
  v_fma_f32 v72, v20, v209, -v214
  s_waitcnt vmcnt(15) lgkmcnt(12)
  v_mfma_f32_16x16x32_bf16 v[48:51], v[144:147], a[48:51], v[48:51]
  buffer_load_dwordx4 v3, s[24:27], s20 offen offset:3072 sc1 lds
  s_add_u32 m0, s19, 24576
  s_add_u32 s20, s17, 45056
  v_mfma_f32_16x16x32_bf16 v[52:55], v[148:151], a[48:51], v[52:55]
  ds_read_b128 v[144:147], v16 offset:28672
  ds_read_b128 v[148:151], v16 offset:29696
  v_mfma_f32_16x16x32_bf16 v[56:59], v[152:155], a[48:51], v[56:59]
  ds_read_b128 v[152:155], v16 offset:30720
  v_fma_f32 v73, v21, v209, -v214
  v_mfma_f32_16x16x32_bf16 v[60:63], v[156:159], a[48:51], v[60:63]
  ds_read_b128 v[156:159], v16 offset:31744
  v_fma_f32 v76, v24, v209, -v214
  s_waitcnt lgkmcnt(12)
  v_mfma_f32_16x16x32_bf16 v[64:67], v[96:99], a[48:51], v[64:67]
  buffer_load_dwordx4 v3, s[24:27], s20 offen sc1 lds
  s_add_u32 s20, s17, 102400
  ds_read_b128 v[96:99], v3 offset:40960
  s_waitcnt vmcnt(16)
  v_mfma_f32_16x16x32_bf16 v[48:51], v[100:103], a[52:55], v[48:51]
  ds_read_b128 v[100:103], v3 offset:41984
  v_fma_f32 v77, v25, v209, -v214
  v_mfma_f32_16x16x32_bf16 v[52:55], v[104:107], a[52:55], v[52:55]
  ds_read_b128 v[104:107], v3 offset:43008
  v_lshlrev_b32 v28, 16, v164
  v_mfma_f32_16x16x32_bf16 v[56:59], v[108:111], a[52:55], v[56:59]
  ds_read_b128 v[108:111], v3 offset:44032
  v_and_b32 v32, 0xffff0000, v164
  s_waitcnt lgkmcnt(12)
  v_mfma_f32_16x16x32_bf16 v[60:63], v[112:115], a[52:55], v[60:63]
  buffer_load_dwordx4 a[180:183], v3, s[24:27], s20 offen offset:0 sc1
  ds_read_b128 v[112:115], v3 offset:45056
  v_mfma_f32_16x16x32_bf16 v[64:67], v[116:119], a[52:55], v[64:67]
  ds_read_b128 v[116:119], v3 offset:46080
  v_lshlrev_b32 v29, 16, v165
  s_waitcnt vmcnt(16)
  v_mfma_f32_16x16x32_bf16 v[48:51], v[120:123], a[56:59], v[48:51]
  ds_read_b128 v[120:123], v3 offset:47104
  v_and_b32 v33, 0xffff0000, v165
  v_mfma_f32_16x16x32_bf16 v[52:55], v[124:127], a[56:59], v[52:55]
  ds_read_b128 v[124:127], v3 offset:48128
  v_fma_f32 v74, v22, v209, -v214
  s_waitcnt lgkmcnt(12)
  v_mfma_f32_16x16x32_bf16 v[56:59], v[128:131], a[56:59], v[56:59]
  buffer_load_dwordx4 a[184:187], v3, s[24:27], s20 offen offset:1024 sc1
  ds_read_b128 v[128:131], v3 offset:49152
  v_mfma_f32_16x16x32_bf16 v[60:63], v[132:135], a[56:59], v[60:63]
  ds_read_b128 v[132:135], v3 offset:50176
  v_fma_f32 v75, v23, v209, -v214
  v_mfma_f32_16x16x32_bf16 v[64:67], v[136:139], a[56:59], v[64:67]
  ds_read_b128 v[136:139], v3 offset:51200
  v_fma_f32 v78, v26, v209, -v214
  s_waitcnt vmcnt(16)
  v_mfma_f32_16x16x32_bf16 v[48:51], v[140:143], a[60:63], v[48:51]
  ds_read_b128 v[140:143], v3 offset:52224
  v_fma_f32 v79, v27, v209, -v214
  s_waitcnt lgkmcnt(12)
  v_mfma_f32_16x16x32_bf16 v[52:55], v[144:147], a[60:63], v[52:55]
  buffer_load_dwordx4 a[188:191], v3, s[24:27], s20 offen offset:2048 sc1
  ds_read_b128 v[144:147], v3 offset:53248
  v_mfma_f32_16x16x32_bf16 v[56:59], v[148:151], a[60:63], v[56:59]
  ds_read_b128 v[148:151], v3 offset:54272
  v_lshlrev_b32 v30, 16, v166
  v_mfma_f32_16x16x32_bf16 v[60:63], v[152:155], a[60:63], v[60:63]
  ds_read_b128 v[152:155], v3 offset:55296
  v_and_b32 v34, 0xffff0000, v166
  v_mfma_f32_16x16x32_bf16 v[64:67], v[156:159], a[60:63], v[64:67]
  ds_read_b128 v[156:159], v3 offset:56320
  v_lshlrev_b32 v31, 16, v167
  s_waitcnt vmcnt(16) lgkmcnt(12)
  v_mfma_f32_16x16x32_bf16 v[48:51], v[96:99], a[64:67], v[48:51]
  buffer_load_dwordx4 a[192:195], v3, s[24:27], s20 offen offset:3072 sc1
  s_add_u32 s20, s17, 106496
  s_add_u32 s32, s41, 20971520
  ds_read_b128 v[96:99], v3 offset:57344
  v_mfma_f32_16x16x32_bf16 v[52:55], v[100:103], a[64:67], v[52:55]
  ds_read_b128 v[100:103], v3 offset:58368
  v_and_b32 v35, 0xffff0000, v167
  v_mfma_f32_16x16x32_bf16 v[56:59], v[104:107], a[64:67], v[56:59]
  ds_read_b128 v[104:107], v3 offset:59392
  v_lshlrev_b32 v36, 16, v168
  v_mfma_f32_16x16x32_bf16 v[60:63], v[108:111], a[64:67], v[60:63]
  ds_read_b128 v[108:111], v3 offset:60416
  v_and_b32 v37, 0xffff0000, v168
  buffer_load_dwordx4 a[196:199], v3, s[24:27], s20 offen offset:0 sc1
  s_waitcnt lgkmcnt(12)
  v_mfma_f32_16x16x32_bf16 v[64:67], v[112:115], a[64:67], v[64:67]
  v_lshlrev_b32 v38, 16, v169
  v_and_b32 v39, 0xffff0000, v169
  s_waitcnt vmcnt(17)
  v_mfma_f32_16x16x32_bf16 v[48:51], v[116:119], a[68:71], v[48:51]
  v_fma_f32 v80, v28, v209, -v214
  v_fma_f32 v81, v29, v209, -v214
  v_mfma_f32_16x16x32_bf16 v[52:55], v[120:123], a[68:71], v[52:55]
  v_fma_f32 v84, v32, v209, -v214
  v_fma_f32 v85, v33, v209, -v214
  v_mfma_f32_16x16x32_bf16 v[56:59], v[124:127], a[68:71], v[56:59]
  v_fma_f32 v82, v30, v209, -v214
  v_fma_f32 v83, v31, v209, -v214
  s_waitcnt lgkmcnt(8)
  v_mfma_f32_16x16x32_bf16 v[60:63], v[128:131], a[68:71], v[60:63]
  v_fma_f32 v86, v34, v209, -v214
  v_fma_f32 v87, v35, v209, -v214
  v_mfma_f32_16x16x32_bf16 v[64:67], v[132:135], a[68:71], v[64:67]
  v_fma_f32 v88, v36, v209, -v214
  v_fma_f32 v89, v37, v209, -v214
  s_waitcnt vmcnt(16)
  v_mfma_f32_16x16x32_bf16 v[48:51], v[136:139], a[72:75], v[48:51]
  v_fma_f32 v90, v38, v209, -v214
  v_fma_f32 v91, v39, v209, -v214
  v_mfma_f32_16x16x32_bf16 v[52:55], v[140:143], a[72:75], v[52:55]
  s_add_u32 s33, s42, 20971520
  s_lshl_b32 s35, s29, 14
  s_waitcnt lgkmcnt(7)
  v_mfma_f32_16x16x32_bf16 v[56:59], v[144:147], a[72:75], v[56:59]
  s_add_u32 s35, s35, s34
  s_add_u32 s35, s35, 37289984
  s_waitcnt lgkmcnt(6)
  v_mfma_f32_16x16x32_bf16 v[60:63], v[148:151], a[72:75], v[60:63]
  s_waitcnt lgkmcnt(5)
  v_mfma_f32_16x16x32_bf16 v[64:67], v[152:155], a[72:75], v[64:67]
  s_waitcnt vmcnt(15) lgkmcnt(4)
  v_mfma_f32_16x16x32_bf16 v[48:51], v[156:159], a[76:79], v[48:51]
  s_waitcnt lgkmcnt(3)
  v_mfma_f32_16x16x32_bf16 v[52:55], v[96:99], a[76:79], v[52:55]
  s_waitcnt lgkmcnt(2)
  v_mfma_f32_16x16x32_bf16 v[56:59], v[100:103], a[76:79], v[56:59]
  s_waitcnt lgkmcnt(1)
  v_mfma_f32_16x16x32_bf16 v[60:63], v[104:107], a[76:79], v[60:63]
  s_waitcnt lgkmcnt(0)
  v_mfma_f32_16x16x32_bf16 v[64:67], v[108:111], a[76:79], v[64:67]
  v_pk_add_f32 v[48:49], v[48:49], v[72:73]
  s_nop 0
  v_pk_add_f32 v[52:53], v[52:53], v[76:77]
  v_pk_add_f32 v[50:51], v[50:51], v[74:75]
  v_pk_add_f32 v[54:55], v[54:55], v[78:79]
  v_cvt_pk_bf16_f32 v184, v48, v52
  v_cvt_pk_bf16_f32 v185, v49, v53
  v_pk_add_f32 v[56:57], v[56:57], v[80:81]
  v_pk_add_f32 v[60:61], v[60:61], v[84:85]
  v_cvt_pk_bf16_f32 v186, v50, v54
  v_cvt_pk_bf16_f32 v187, v51, v55
  buffer_store_dwordx4 v[184:187], v3, s[24:27], s32 offen offset:0 sc1
  v_dot2c_f32_bf16 v4, s38, v184
  v_dot2c_f32_bf16 v5, v184, v184
  v_dot2c_f32_bf16 v224, s38, v185
  v_dot2c_f32_bf16 v225, v185, v185
  v_pk_add_f32 v[58:59], v[58:59], v[82:83]
  v_pk_add_f32 v[62:63], v[62:63], v[86:87]
  v_pk_add_f32 v[64:65], v[64:65], v[88:89]
  v_pk_add_f32 v[66:67], v[66:67], v[90:91]
  v_cvt_pk_bf16_f32 v188, v56, v60
  v_cvt_pk_bf16_f32 v189, v57, v61
  v_dot2c_f32_bf16 v4, s38, v186
  v_dot2c_f32_bf16 v5, v186, v186
  v_dot2c_f32_bf16 v224, s38, v187
  v_dot2c_f32_bf16 v225, v187, v187
  v_cvt_pk_bf16_f32 v190, v58, v62
  v_cvt_pk_bf16_f32 v191, v59, v63
  buffer_store_dwordx4 v[188:191], v3, s[24:27], s32 offen offset:1024 sc1
  v_cvt_pk_bf16_f32 v192, v64, v65
  v_cvt_pk_bf16_f32 v193, v66, v67
  v_dot2c_f32_bf16 v4, s38, v188
  v_dot2c_f32_bf16 v5, v188, v188
  v_dot2c_f32_bf16 v224, s38, v189
  v_dot2c_f32_bf16 v225, v189, v189
  v_mov_b32 v196, v192
  v_mov_b32 v197, v193
  v_dot2c_f32_bf16 v4, s38, v190
  v_dot2c_f32_bf16 v5, v190, v190
  v_dot2c_f32_bf16 v224, s38, v191
  v_dot2c_f32_bf16 v225, v191, v191
  v_dot2c_f32_bf16 v4, s38, v196
  v_dot2c_f32_bf16 v5, v196, v196
  v_dot2c_f32_bf16 v224, s38, v197
  v_dot2c_f32_bf16 v225, v197, v197
  v_cvt_pk_bf16_f32 v194, v64, v65
  v_cvt_pk_bf16_f32 v195, v66, v67
  v_add_f32 v4, v4, v224
  v_add_f32 v5, v5, v225
  v_permlane16_swap_b32 v192, v194
  v_permlane16_swap_b32 v193, v195
  v_permlane16_swap_b32 v4, v5
  v_add_f32 v4, v4, v5
  v_mov_b32 v5, v4
  s_nop 1
  v_permlane32_swap_b32 v4, v5
  v_add_f32 v4, v4, v5
  s_mov_b64 exec, s[54:55]
  buffer_store_dwordx4 v[192:195], v8, s[24:27], s33 offen sc1
  s_mov_b64 exec, s[50:51]
  buffer_store_dword v4, v6, s[24:27], s35 offen sc1
  s_mov_b64 exec, -1
  s_lshl_b32 s46, s9, 4
  s_lshr_b32 s33, s8, 4
  s_lshl_b32 s33, s33, 3
  s_add_u32 s46, s46, s33
  s_lshl_b32 s33, s3, 1
  s_add_u32 s46, s46, s33
  s_and_b32 s47, s8, 15
  s_lshl_b32 s48, s46, 7
  s_mul_i32 s36, s46, 20480
  s_add_u32 s36, s36, 20971520
  s_add_u32 s37, s36, 20480
  s_mul_i32 s49, s47, 384
  s_add_u32 s49, s49, 37030400
  s_lshl_b32 s15, s28, 3
  s_add_u32 s15, s15, s29
  s_lshl_b32 s15, s15, 2
  v_mov_b32 v192, v196
  v_mov_b32 v193, v197
  s_add_u32 s15, s15, 37057024
  v_lshlrev_b32 v96, 16, v184
  v_and_b32 v100, 0xffff0000, v184
  v_lshlrev_b32 v97, 16, v185
  v_and_b32 v101, 0xffff0000, v185
  v_lshlrev_b32 v98, 16, v186
  v_and_b32 v102, 0xffff0000, v186
  v_lshlrev_b32 v99, 16, v187
  v_and_b32 v103, 0xffff0000, v187
  v_lshlrev_b32 v104, 16, v188
  v_and_b32 v108, 0xffff0000, v188
  v_lshlrev_b32 v105, 16, v189
  v_and_b32 v109, 0xffff0000, v189
  v_lshlrev_b32 v106, 16, v190
  v_and_b32 v110, 0xffff0000, v190
  v_lshlrev_b32 v107, 16, v191
  v_and_b32 v111, 0xffff0000, v191
  v_lshlrev_b32 v112, 16, v192
  v_and_b32 v113, 0xffff0000, v192
  v_lshlrev_b32 v114, 16, v193
  v_and_b32 v115, 0xffff0000, v193
  s_lshl_b32 s14, s46, 5
  v_pk_add_f32 v[20:21], v[20:21], v[96:97]
  v_pk_add_f32 v[22:23], v[22:23], v[98:99]
  v_pk_add_f32 v[24:25], v[24:25], v[100:101]
  v_pk_add_f32 v[26:27], v[26:27], v[102:103]
  v_pk_add_f32 v[28:29], v[28:29], v[104:105]
  v_pk_add_f32 v[30:31], v[30:31], v[106:107]
  v_pk_add_f32 v[32:33], v[32:33], v[108:109]
  v_pk_add_f32 v[34:35], v[34:35], v[110:111]
  v_pk_add_f32 v[36:37], v[36:37], v[112:113]
  v_pk_add_f32 v[38:39], v[38:39], v[114:115]
  s_add_u32 s14, s14, 37057024
  s_waitcnt vmcnt(0)
  s_nop 4
  s_movk_i32 s22, 0x7fff
  s_cmp_lg_u32 s56, 0
  s_cbranch_scc1 KM_P5_FAR
  buffer_store_dword v9, v12, s[24:27], s15 offen
  s_barrier
KM_P5_L:
  buffer_load_dword v7, v10, s[24:27], s14 offen sc1
  s_waitcnt vmcnt(0)
  v_cmp_gt_u32 vcc, 1, v7
  s_sub_u32 s22, s22, 1
  s_cbranch_scc1 KM_P5_OUT
  s_cbranch_vccnz KM_P5_L
  s_branch KM_P5_OUT
KM_P5_FAR:
  s_barrier
  s_cmp_lg_u32 s3, 0
  s_cbranch_scc1 KM_P5_END
  s_mov_b64 exec, 1
  buffer_atomic_add v9, v12, s[24:27], s11 offen sc1
  s_mov_b64 exec, 1
KM_P5:
  v_mov_b32 v7, 0
  buffer_atomic_add v7, v12, s[24:27], s11 offen sc0 sc1
  s_waitcnt vmcnt(0)
  v_cmp_gt_u32 vcc, 16, v7
  s_sub_u32 s22, s22, 1
  s_cbranch_scc1 KM_P5_END
  s_cbranch_vccnz KM_P5
KM_P5_END:
  s_mov_b64 exec, -1
  s_barrier
KM_P5_OUT:
  s_nop 4
C_P5:
  buffer_load_dwordx4 a[0:3], v3, s[24:27], s36 offen offset:0 sc1
  v_lshrrev_b32 v4, 1, v2
  v_lshlrev_b32 v4, 16, v4
  v_and_b32 v5, 1, v2
  v_lshl_add_u32 v4, v5, 6, v4
  v_lshl_add_u32 v4, v1, 2, v4
  v_lshlrev_b32 v6, 4, v2
  ds_read_b128 v[96:99], v3 offset:61440
  ds_read_b128 v[100:103], v3 offset:62464
  ds_read_b128 v[104:107], v3 offset:63488
  ds_read_b128 v[108:111], v3 offset:64512
  ds_read_b128 v[112:115], v15 offset:0
  ds_read_b128 v[116:119], v15 offset:1024
  ds_read_b128 v[120:123], v15 offset:2048
  ds_read_b128 v[124:127], v15 offset:3072
  ds_read_b128 v[128:131], v15 offset:4096
  buffer_load_dwordx4 a[4:7], v3, s[24:27], s37 offen offset:0 sc1
  ds_read_b128 v[132:135], v15 offset:5120
  ds_read_b128 v[136:139], v15 offset:6144
  ds_read_b128 v[140:143], v15 offset:7168
  ds_read_b128 v[144:147], v15 offset:8192
  ds_read_b128 v[148:151], v15 offset:9216
  ds_read_b128 v[152:155], v15 offset:10240
  ds_read_b128 v[156:159], v15 offset:11264
  ds_write_b128 v18, a[200:203] offset:16384
  buffer_load_dwordx4 a[8:11], v3, s[24:27], s36 offen offset:1024 sc1
  ds_write_b128 v18, a[220:223] offset:36864
  buffer_load_dwordx4 a[12:15], v3, s[24:27], s37 offen offset:1024 sc1
  ds_write_b128 v18, a[180:183] offset:57344
  ds_write_b128 v18, a[204:207] offset:17408
  buffer_load_dwordx4 a[16:19], v3, s[24:27], s36 offen offset:2048 sc1
  ds_write_b128 v18, a[224:227] offset:37888
  buffer_load_dwordx4 a[20:23], v3, s[24:27], s37 offen offset:2048 sc1
  ds_write_b128 v18, a[184:187] offset:58368
  buffer_load_dwordx4 a[24:27], v3, s[24:27], s36 offen offset:3072 sc1
  s_add_u32 s36, s36, 4096
  ds_write_b128 v18, a[208:211] offset:18432
  buffer_load_dwordx4 a[28:31], v3, s[24:27], s37 offen offset:3072 sc1
  s_add_u32 s37, s37, 4096
  ds_write_b128 v18, a[228:231] offset:38912
  buffer_load_dwordx4 a[32:35], v3, s[24:27], s36 offen offset:0 sc1
  ds_write_b128 v18, a[188:191] offset:59392
  ds_write_b128 v18, a[212:215] offset:19456
  buffer_load_dwordx4 a[36:39], v3, s[24:27], s37 offen offset:0 sc1
  ds_write_b128 v18, a[232:235] offset:39936
  buffer_load_dwordx4 a[40:43], v3, s[24:27], s36 offen offset:1024 sc1
  ds_write_b128 v18, a[192:195] offset:60416
  buffer_load_dwordx4 a[44:47], v3, s[24:27], s37 offen offset:1024 sc1
  ds_write_b128 v18, a[216:219] offset:20480
  buffer_load_dwordx4 a[48:51], v3, s[24:27], s36 offen offset:2048 sc1
  ds_write_b128 v18, a[236:239] offset:40960
  ds_write_b128 v18, a[196:199] offset:61440
  buffer_load_dwordx4 a[52:55], v3, s[24:27], s37 offen offset:2048 sc1
  buffer_load_dwordx4 a[56:59], v3, s[24:27], s36 offen offset:3072 sc1
  s_add_u32 s36, s36, 4096
  buffer_load_dwordx4 a[60:63], v3, s[24:27], s37 offen offset:3072 sc1
  s_add_u32 s37, s37, 4096
  s_waitcnt vmcnt(15) lgkmcnt(15)
  v_mfma_f32_16x16x32_bf16 v[48:51], v[96:99], a[0:3], 0
  v_mfma_f32_16x16x32_bf16 v[56:59], v[100:103], a[0:3], 0
  buffer_load_dwordx4 a[64:67], v3, s[24:27], s36 offen offset:0 sc1
  v_mfma_f32_16x16x32_bf16 v[64:67], v[104:107], a[0:3], 0
  v_mfma_f32_16x16x32_bf16 v[72:75], v[108:111], a[0:3], 0
  s_waitcnt vmcnt(15)
  v_mfma_f32_16x16x32_bf16 v[52:55], v[96:99], a[4:7], 0
  ds_read_b128 v[96:99], v15 offset:12288
  v_mfma_f32_16x16x32_bf16 v[60:63], v[100:103], a[4:7], 0
  buffer_load_dwordx4 a[68:71], v3, s[24:27], s37 offen offset:0 sc1
  ds_read_b128 v[100:103], v15 offset:13312
  v_mfma_f32_16x16x32_bf16 v[68:71], v[104:107], a[4:7], 0
  ds_read_b128 v[104:107], v15 offset:14336
  v_mfma_f32_16x16x32_bf16 v[76:79], v[108:111], a[4:7], 0
  ds_read_b128 v[108:111], v15 offset:15360
  s_waitcnt vmcnt(15)
  v_mfma_f32_16x16x32_bf16 v[48:51], v[112:115], a[8:11], v[48:51]
  v_mfma_f32_16x16x32_bf16 v[56:59], v[116:119], a[8:11], v[56:59]
  buffer_load_dwordx4 a[72:75], v3, s[24:27], s36 offen offset:1024 sc1
  v_mfma_f32_16x16x32_bf16 v[64:67], v[120:123], a[8:11], v[64:67]
  v_mfma_f32_16x16x32_bf16 v[72:75], v[124:127], a[8:11], v[72:75]
  s_waitcnt vmcnt(15)
  v_mfma_f32_16x16x32_bf16 v[52:55], v[112:115], a[12:15], v[52:55]
  ds_read_b128 v[112:115], v3 offset:0
  v_mfma_f32_16x16x32_bf16 v[60:63], v[116:119], a[12:15], v[60:63]
  buffer_load_dwordx4 a[76:79], v3, s[24:27], s37 offen offset:1024 sc1
  ds_read_b128 v[116:119], v3 offset:1024
  v_mfma_f32_16x16x32_bf16 v[68:71], v[120:123], a[12:15], v[68:71]
  ds_read_b128 v[120:123], v3 offset:2048
  v_mfma_f32_16x16x32_bf16 v[76:79], v[124:127], a[12:15], v[76:79]
  ds_read_b128 v[124:127], v3 offset:3072
  s_waitcnt vmcnt(15)
  v_mfma_f32_16x16x32_bf16 v[48:51], v[128:131], a[16:19], v[48:51]
  v_mfma_f32_16x16x32_bf16 v[56:59], v[132:135], a[16:19], v[56:59]
  buffer_load_dwordx4 a[80:83], v3, s[24:27], s36 offen offset:2048 sc1
  v_mfma_f32_16x16x32_bf16 v[64:67], v[136:139], a[16:19], v[64:67]
  v_mfma_f32_16x16x32_bf16 v[72:75], v[140:143], a[16:19], v[72:75]
  s_waitcnt vmcnt(15)
  v_mfma_f32_16x16x32_bf16 v[52:55], v[128:131], a[20:23], v[52:55]
  ds_read_b128 v[128:131], v3 offset:4096
  v_mfma_f32_16x16x32_bf16 v[60:63], v[132:135], a[20:23], v[60:63]
  buffer_load_dwordx4 a[84:87], v3, s[24:27], s37 offen offset:2048 sc1
  ds_read_b128 v[132:135], v3 offset:5120
  v_mfma_f32_16x16x32_bf16 v[68:71], v[136:139], a[20:23], v[68:71]
  ds_read_b128 v[136:139], v3 offset:6144
  v_mfma_f32_16x16x32_bf16 v[76:79], v[140:143], a[20:23], v[76:79]
  ds_read_b128 v[140:143], v3 offset:7168
  s_waitcnt vmcnt(15)
  v_mfma_f32_16x16x32_bf16 v[48:51], v[144:147], a[24:27], v[48:51]
  v_mfma_f32_16x16x32_bf16 v[56:59], v[148:151], a[24:27], v[56:59]
  buffer_load_dwordx4 a[88:91], v3, s[24:27], s36 offen offset:3072 sc1
  s_add_u32 s36, s36, 4096
  v_mfma_f32_16x16x32_bf16 v[64:67], v[152:155], a[24:27], v[64:67]
  v_mfma_f32_16x16x32_bf16 v[72:75], v[156:159], a[24:27], v[72:75]
  s_waitcnt vmcnt(15)
  v_mfma_f32_16x16x32_bf16 v[52:55], v[144:147], a[28:31], v[52:55]
  ds_read_b128 v[144:147], v3 offset:8192
  v_mfma_f32_16x16x32_bf16 v[60:63], v[148:151], a[28:31], v[60:63]
  buffer_load_dwordx4 a[92:95], v3, s[24:27], s37 offen offset:3072 sc1
  s_add_u32 s37, s37, 4096
  s_add_u32 s32, s48, 37289984
  v_mfma_f32_16x16x32_bf16 v[68:71], v[152:155], a[28:31], v[68:71]
  ds_read_b128 v[148:151], v3 offset:9216
  ds_read_b128 v[152:155], v3 offset:10240
  v_mfma_f32_16x16x32_bf16 v[76:79], v[156:159], a[28:31], v[76:79]
  ds_read_b128 v[156:159], v3 offset:11264
  s_waitcnt vmcnt(15) lgkmcnt(12)
  v_mfma_f32_16x16x32_bf16 v[48:51], v[96:99], a[32:35], v[48:51]
  v_mfma_f32_16x16x32_bf16 v[56:59], v[100:103], a[32:35], v[56:59]
  buffer_load_dword v220, v4, s[24:27], s32 offen offset:0 sc1
  v_mfma_f32_16x16x32_bf16 v[64:67], v[104:107], a[32:35], v[64:67]
  v_mfma_f32_16x16x32_bf16 v[72:75], v[108:111], a[32:35], v[72:75]
  buffer_load_dword v224, v4, s[24:27], s32 offen offset:128 sc1
  s_add_u32 s32, s32, 16384
  s_waitcnt vmcnt(16)
  v_mfma_f32_16x16x32_bf16 v[52:55], v[96:99], a[36:39], v[52:55]
  ds_read_b128 v[96:99], v3 offset:12288
  v_mfma_f32_16x16x32_bf16 v[60:63], v[100:103], a[36:39], v[60:63]
  buffer_load_dword v221, v4, s[24:27], s32 offen offset:0 sc1
  ds_read_b128 v[100:103], v3 offset:13312
  v_mfma_f32_16x16x32_bf16 v[68:71], v[104:107], a[36:39], v[68:71]
  ds_read_b128 v[104:107], v3 offset:14336
  v_mfma_f32_16x16x32_bf16 v[76:79], v[108:111], a[36:39], v[76:79]
  buffer_load_dword v225, v4, s[24:27], s32 offen offset:128 sc1
  s_add_u32 s32, s32, 16384
  ds_read_b128 v[108:111], v3 offset:15360
  s_waitcnt vmcnt(17) lgkmcnt(12)
  v_mfma_f32_16x16x32_bf16 v[48:51], v[112:115], a[40:43], v[48:51]
  v_mfma_f32_16x16x32_bf16 v[56:59], v[116:119], a[40:43], v[56:59]
  buffer_load_dword v222, v4, s[24:27], s32 offen offset:0 sc1
  v_mfma_f32_16x16x32_bf16 v[64:67], v[120:123], a[40:43], v[64:67]
  v_mfma_f32_16x16x32_bf16 v[72:75], v[124:127], a[40:43], v[72:75]
  buffer_load_dword v226, v4, s[24:27], s32 offen offset:128 sc1
  s_add_u32 s32, s32, 16384
  s_waitcnt vmcnt(18)
  v_mfma_f32_16x16x32_bf16 v[52:55], v[112:115], a[44:47], v[52:55]
  ds_read_b128 v[112:115], v3 offset:16384
  v_mfma_f32_16x16x32_bf16 v[60:63], v[116:119], a[44:47], v[60:63]
  buffer_load_dword v223, v4, s[24:27], s32 offen offset:0 sc1
  ds_read_b128 v[116:119], v3 offset:17408
  v_mfma_f32_16x16x32_bf16 v[68:71], v[120:123], a[44:47], v[68:71]
  ds_read_b128 v[120:123], v3 offset:18432
  v_mfma_f32_16x16x32_bf16 v[76:79], v[124:127], a[44:47], v[76:79]
  buffer_load_dword v227, v4, s[24:27], s32 offen offset:128 sc1
  ds_read_b128 v[124:127], v3 offset:19456
  s_waitcnt vmcnt(19) lgkmcnt(12)
  v_mfma_f32_16x16x32_bf16 v[48:51], v[128:131], a[48:51], v[48:51]
  v_mfma_f32_16x16x32_bf16 v[56:59], v[132:135], a[48:51], v[56:59]
  buffer_load_dwordx4 v[160:163], v6, s[24:27], s49 offen offset:0 sc1
  v_mfma_f32_16x16x32_bf16 v[64:67], v[136:139], a[48:51], v[64:67]
  v_mfma_f32_16x16x32_bf16 v[72:75], v[140:143], a[48:51], v[72:75]
  s_waitcnt vmcnt(19)
  v_mfma_f32_16x16x32_bf16 v[52:55], v[128:131], a[52:55], v[52:55]
  ds_read_b128 v[128:131], v3 offset:20480
  v_mfma_f32_16x16x32_bf16 v[60:63], v[132:135], a[52:55], v[60:63]
  buffer_load_dwordx4 v[164:167], v6, s[24:27], s49 offen offset:64 sc1
  ds_read_b128 v[132:135], v3 offset:21504
  v_mfma_f32_16x16x32_bf16 v[68:71], v[136:139], a[52:55], v[68:71]
  ds_read_b128 v[136:139], v3 offset:22528
  v_mfma_f32_16x16x32_bf16 v[76:79], v[140:143], a[52:55], v[76:79]
  ds_read_b128 v[140:143], v3 offset:23552
  s_waitcnt vmcnt(19) lgkmcnt(12)
  v_mfma_f32_16x16x32_bf16 v[48:51], v[144:147], a[56:59], v[48:51]
  v_mfma_f32_16x16x32_bf16 v[56:59], v[148:151], a[56:59], v[56:59]
  buffer_load_dwordx4 v[168:171], v6, s[24:27], s49 offen offset:128 sc1
  v_mfma_f32_16x16x32_bf16 v[64:67], v[152:155], a[56:59], v[64:67]
  v_mfma_f32_16x16x32_bf16 v[72:75], v[156:159], a[56:59], v[72:75]
  s_waitcnt vmcnt(19)
  v_mfma_f32_16x16x32_bf16 v[52:55], v[144:147], a[60:63], v[52:55]
  ds_read_b128 v[144:147], v3 offset:24576
  v_mfma_f32_16x16x32_bf16 v[60:63], v[148:151], a[60:63], v[60:63]
  buffer_load_dwordx4 v[172:175], v6, s[24:27], s49 offen offset:192 sc1
  ds_read_b128 v[148:151], v3 offset:25600
  v_mfma_f32_16x16x32_bf16 v[68:71], v[152:155], a[60:63], v[68:71]
  ds_read_b128 v[152:155], v3 offset:26624
  v_mfma_f32_16x16x32_bf16 v[76:79], v[156:159], a[60:63], v[76:79]
  ds_read_b128 v[156:159], v3 offset:27648
  s_waitcnt vmcnt(19) lgkmcnt(12)
  v_mfma_f32_16x16x32_bf16 v[48:51], v[96:99], a[64:67], v[48:51]
  v_mfma_f32_16x16x32_bf16 v[56:59], v[100:103], a[64:67], v[56:59]
  buffer_load_dwordx4 v[176:179], v6, s[24:27], s49 offen offset:256 sc1
  v_mfma_f32_16x16x32_bf16 v[64:67], v[104:107], a[64:67], v[64:67]
  v_mfma_f32_16x16x32_bf16 v[72:75], v[108:111], a[64:67], v[72:75]
  s_waitcnt vmcnt(19)
  v_mfma_f32_16x16x32_bf16 v[52:55], v[96:99], a[68:71], v[52:55]
  ds_read_b128 v[96:99], v3 offset:28672
  v_mfma_f32_16x16x32_bf16 v[60:63], v[100:103], a[68:71], v[60:63]
  buffer_load_dwordx4 v[180:183], v6, s[24:27], s49 offen offset:320 sc1
  ds_read_b128 v[100:103], v3 offset:29696
  v_mfma_f32_16x16x32_bf16 v[68:71], v[104:107], a[68:71], v[68:71]
  ds_read_b128 v[104:107], v3 offset:30720
  v_mfma_f32_16x16x32_bf16 v[76:79], v[108:111], a[68:71], v[76:79]
  ds_read_b128 v[108:111], v3 offset:31744
  s_waitcnt vmcnt(19) lgkmcnt(12)
  v_mfma_f32_16x16x32_bf16 v[48:51], v[112:115], a[72:75], v[48:51]
  v_mfma_f32_16x16x32_bf16 v[56:59], v[116:119], a[72:75], v[56:59]
  buffer_load_dwordx4 a[96:99], v3, s[24:27], s36 offen offset:0 sc1
  v_mfma_f32_16x16x32_bf16 v[64:67], v[120:123], a[72:75], v[64:67]
  v_mfma_f32_16x16x32_bf16 v[72:75], v[124:127], a[72:75], v[72:75]
  s_waitcnt vmcnt(19)
  v_mfma_f32_16x16x32_bf16 v[52:55], v[112:115], a[76:79], v[52:55]
  ds_read_b128 v[112:115], v3 offset:32768
  v_mfma_f32_16x16x32_bf16 v[60:63], v[116:119], a[76:79], v[60:63]
  buffer_load_dwordx4 a[100:103], v3, s[24:27], s37 offen offset:0 sc1
  ds_read_b128 v[116:119], v3 offset:33792
  v_mfma_f32_16x16x32_bf16 v[68:71], v[120:123], a[76:79], v[68:71]
  ds_read_b128 v[120:123], v3 offset:34816
  v_mfma_f32_16x16x32_bf16 v[76:79], v[124:127], a[76:79], v[76:79]
  ds_read_b128 v[124:127], v3 offset:35840
  s_waitcnt vmcnt(19) lgkmcnt(12)
  v_mfma_f32_16x16x32_bf16 v[48:51], v[128:131], a[80:83], v[48:51]
  v_mfma_f32_16x16x32_bf16 v[56:59], v[132:135], a[80:83], v[56:59]
  buffer_load_dwordx4 a[104:107], v3, s[24:27], s36 offen offset:1024 sc1
  v_mfma_f32_16x16x32_bf16 v[64:67], v[136:139], a[80:83], v[64:67]
  v_mfma_f32_16x16x32_bf16 v[72:75], v[140:143], a[80:83], v[72:75]
  s_waitcnt vmcnt(19)
  v_mfma_f32_16x16x32_bf16 v[52:55], v[128:131], a[84:87], v[52:55]
  ds_read_b128 v[128:131], v3 offset:36864
  v_mfma_f32_16x16x32_bf16 v[60:63], v[132:135], a[84:87], v[60:63]
  buffer_load_dwordx4 a[108:111], v3, s[24:27], s37 offen offset:1024 sc1
  ds_read_b128 v[132:135], v3 offset:37888
  v_mfma_f32_16x16x32_bf16 v[68:71], v[136:139], a[84:87], v[68:71]
  ds_read_b128 v[136:139], v3 offset:38912
  v_mfma_f32_16x16x32_bf16 v[76:79], v[140:143], a[84:87], v[76:79]
  ds_read_b128 v[140:143], v3 offset:39936
  s_waitcnt vmcnt(19) lgkmcnt(12)
  v_mfma_f32_16x16x32_bf16 v[48:51], v[144:147], a[88:91], v[48:51]
  v_mfma_f32_16x16x32_bf16 v[56:59], v[148:151], a[88:91], v[56:59]
  buffer_load_dwordx4 a[112:115], v3, s[24:27], s36 offen offset:2048 sc1
  v_mfma_f32_16x16x32_bf16 v[64:67], v[152:155], a[88:91], v[64:67]
  v_mfma_f32_16x16x32_bf16 v[72:75], v[156:159], a[88:91], v[72:75]
  s_waitcnt vmcnt(19)
  v_mfma_f32_16x16x32_bf16 v[52:55], v[144:147], a[92:95], v[52:55]
  v_mfma_f32_16x16x32_bf16 v[60:63], v[148:151], a[92:95], v[60:63]
  buffer_load_dwordx4 a[116:119], v3, s[24:27], s37 offen offset:2048 sc1
  v_mfma_f32_16x16x32_bf16 v[68:71], v[152:155], a[92:95], v[68:71]
  v_mfma_f32_16x16x32_bf16 v[76:79], v[156:159], a[92:95], v[76:79]
  buffer_load_dwordx4 a[120:123], v3, s[24:27], s36 offen offset:3072 sc1
  s_add_u32 s36, s36, 4096
  buffer_load_dwordx4 a[124:127], v3, s[24:27], s37 offen offset:3072 sc1
  s_add_u32 s37, s37, 4096
  buffer_load_dwordx4 a[128:131], v3, s[24:27], s36 offen offset:0 sc1
  buffer_load_dwordx4 a[132:135], v3, s[24:27], s37 offen offset:0 sc1
  buffer_load_dwordx4 a[136:139], v3, s[24:27], s36 offen offset:1024 sc1
  buffer_load_dwordx4 a[140:143], v3, s[24:27], s37 offen offset:1024 sc1
  buffer_load_dwordx4 a[144:147], v3, s[24:27], s36 offen offset:2048 sc1
  buffer_load_dwordx4 a[148:151], v3, s[24:27], s37 offen offset:2048 sc1
  buffer_load_dwordx4 a[152:155], v3, s[24:27], s36 offen offset:3072 sc1
  s_add_u32 s36, s36, 4096
  buffer_load_dwordx4 a[156:159], v3, s[24:27], s37 offen offset:3072 sc1
  s_add_u32 s37, s37, 4096
  s_add_u32 m0, s19, 143360
  s_add_u32 s20, s18, 0
  s_waitcnt vmcnt(15) lgkmcnt(8)
  v_mfma_f32_16x16x32_bf16 v[48:51], v[96:99], a[96:99], v[48:51]
  v_mfma_f32_16x16x32_bf16 v[56:59], v[100:103], a[96:99], v[56:59]
  buffer_load_dwordx4 v3, s[24:27], s20 offen offset:0 sc1 lds
  v_mfma_f32_16x16x32_bf16 v[64:67], v[104:107], a[96:99], v[64:67]
  v_mfma_f32_16x16x32_bf16 v[72:75], v[108:111], a[96:99], v[72:75]
  s_waitcnt vmcnt(15)
  v_mfma_f32_16x16x32_bf16 v[52:55], v[96:99], a[100:103], v[52:55]
  v_mfma_f32_16x16x32_bf16 v[60:63], v[100:103], a[100:103], v[60:63]
  buffer_load_dwordx4 v3, s[24:27], s20 offen offset:1024 sc1 lds
  v_mfma_f32_16x16x32_bf16 v[68:71], v[104:107], a[100:103], v[68:71]
  v_mfma_f32_16x16x32_bf16 v[76:79], v[108:111], a[100:103], v[76:79]
  buffer_load_dwordx4 v3, s[24:27], s20 offen offset:2048 sc1 lds
  buffer_load_dwordx4 v3, s[24:27], s20 offen offset:3072 sc1 lds
  s_add_u32 m0, s19, 147456
  s_add_u32 s20, s18, 4096
  buffer_load_dwordx4 v3, s[24:27], s20 offen sc1 lds
  s_barrier
  s_getpc_b64 s[4:5]
PF5:
  v_lshlrev_b32 v4, 7, v0
  v_min_u32 v4, KM_END-PF5, v4
  global_load_dword a243, v4, s[4:5]
  s_add_u32 m0, s19, 40960
  s_add_u32 s20, s18, 20480
  buffer_load_dwordx4 v3, s[24:27], s20 offen offset:0 sc1 lds
  s_mul_i32 s40, s46, 61440
  s_mul_i32 s36, s28, 61440
  ds_read_b128 v[144:147], v15 offset:16384
  ds_read_b128 v[148:151], v15 offset:17408
  ds_read_b128 v[152:155], v15 offset:18432
  ds_read_b128 v[156:159], v15 offset:19456
  ds_read_b128 v[96:99], v15 offset:20480
  ds_read_b128 v[100:103], v15 offset:21504
  ds_read_b128 v[104:107], v15 offset:22528
  ds_read_b128 v[108:111], v15 offset:23552
  s_waitcnt vmcnt(20) lgkmcnt(12)
  v_mfma_f32_16x16x32_bf16 v[48:51], v[112:115], a[104:107], v[48:51]
  v_add_f32 v220, v220, v221
  v_add_f32 v222, v222, v223
  s_waitcnt vmcnt(19)
  v_mfma_f32_16x16x32_bf16 v[52:55], v[112:115], a[108:111], v[52:55]
  buffer_load_dwordx4 v3, s[24:27], s20 offen offset:1024 sc1 lds
  ds_read_b128 v[112:115], v15 offset:24576
  v_mfma_f32_16x16x32_bf16 v[56:59], v[116:119], a[104:107], v[56:59]
  v_add_f32 v224, v224, v225
  v_add_f32 v226, v226, v227
  v_mfma_f32_16x16x32_bf16 v[60:63], v[116:119], a[108:111], v[60:63]
  ds_read_b128 v[116:119], v15 offset:25600
  v_add_f32 v220, v220, v222
  v_mfma_f32_16x16x32_bf16 v[64:67], v[120:123], a[104:107], v[64:67]
  v_add_f32 v224, v224, v226
  v_mov_b32 v45, s56
  v_mfma_f32_16x16x32_bf16 v[68:71], v[120:123], a[108:111], v[68:71]
  buffer_load_dwordx4 v3, s[24:27], s20 offen offset:2048 sc1 lds
  ds_read_b128 v[120:123], v15 offset:26624
  v_mfma_f32_16x16x32_bf16 v[72:75], v[124:127], a[104:107], v[72:75]
  v_permlane32_swap_b32 v220, v224
  v_add_f32 v220, v220, v224
  v_mfma_f32_16x16x32_bf16 v[76:79], v[124:127], a[108:111], v[76:79]
  ds_read_b128 v[124:127], v15 offset:27648
  v_mov_b32 v221, v220
  s_waitcnt vmcnt(20) lgkmcnt(12)
  v_mfma_f32_16x16x32_bf16 v[48:51], v[128:131], a[112:115], v[48:51]
  v_permlane16_swap_b32 v220, v221
  v_mul_f32 v220, 0x3acccccd, v220
  s_waitcnt vmcnt(19)
  v_mfma_f32_16x16x32_bf16 v[52:55], v[128:131], a[116:119], v[52:55]
  buffer_load_dwordx4 v3, s[24:27], s20 offen offset:3072 sc1 lds
  s_add_u32 m0, s19, 45056
  s_add_u32 s20, s18, 24576
  v_mfma_f32_16x16x32_bf16 v[56:59], v[132:135], a[112:115], v[56:59]
  ds_read_b128 v[128:131], v15 offset:28672
  v_mul_f32 v221, 0x3acccccd, v221
  v_mfma_f32_16x16x32_bf16 v[60:63], v[132:135], a[116:119], v[60:63]
  ds_read_b128 v[132:135], v15 offset:29696
  v_fma_f32 v221, -v220, v220, v221
  v_mfma_f32_16x16x32_bf16 v[64:67], v[136:139], a[112:115], v[64:67]
  v_max_f32 v221, 0, v221
  v_add_f32 v221, 0x3727c5ac, v221
  v_mfma_f32_16x16x32_bf16 v[68:71], v[136:139], a[116:119], v[68:71]
  buffer_load_dwordx4 v3, s[24:27], s20 offen sc1 lds
  s_add_u32 m0, s19, 61440
  s_add_u32 s20, s18, 40960
  v_mfma_f32_16x16x32_bf16 v[72:75], v[140:143], a[112:115], v[72:75]
  ds_read_b128 v[136:139], v15 offset:30720
  v_rsq_f32 v210, v221
  v_mfma_f32_16x16x32_bf16 v[76:79], v[140:143], a[116:119], v[76:79]
  ds_read_b128 v[140:143], v15 offset:31744
  v_mul_f32 v240, v210, v221
  s_waitcnt vmcnt(20) lgkmcnt(12)
  v_mfma_f32_16x16x32_bf16 v[48:51], v[144:147], a[120:123], v[48:51]
  v_mul_f32 v224, v210, v210
  v_mov_b32 v214, v220
  buffer_load_dwordx4 v3, s[24:27], s20 offen offset:0 sc1 lds
  s_waitcnt vmcnt(20)
  v_mfma_f32_16x16x32_bf16 v[52:55], v[144:147], a[124:127], v[52:55]
  ds_read_b128 v[144:147], v15 offset:32768
  v_mov_b32 v216, v220
  v_mfma_f32_16x16x32_bf16 v[56:59], v[148:151], a[120:123], v[56:59]
  v_mul_f32 v210, 0xc0135761, v210
  v_mul_f32 v224, 0x3d372713, v224
  v_mfma_f32_16x16x32_bf16 v[60:63], v[148:151], a[124:127], v[60:63]
  ds_read_b128 v[148:151], v15 offset:33792
  v_mul_f32 v224, v210, v224
  v_mfma_f32_16x16x32_bf16 v[64:67], v[152:155], a[120:123], v[64:67]
  v_mov_b32 v212, v210
  buffer_load_dwordx4 v3, s[24:27], s20 offen offset:1024 sc1 lds
  v_mfma_f32_16x16x32_bf16 v[68:71], v[152:155], a[124:127], v[68:71]
  ds_read_b128 v[152:155], v15 offset:34816
  v_mov_b32 v226, v224
  v_mfma_f32_16x16x32_bf16 v[72:75], v[156:159], a[120:123], v[72:75]
  v_permlane32_swap_b32 v214, v216
  v_permlane32_swap_b32 v210, v212
  v_mfma_f32_16x16x32_bf16 v[76:79], v[156:159], a[124:127], v[76:79]
  ds_read_b128 v[156:159], v15 offset:35840
  v_permlane32_swap_b32 v224, v226
  s_waitcnt vmcnt(20) lgkmcnt(12)
  v_mfma_f32_16x16x32_bf16 v[48:51], v[96:99], a[128:131], v[48:51]
  v_mov_b32 v242, v240
  buffer_load_dwordx4 v3, s[24:27], s20 offen offset:2048 sc1 lds
  s_waitcnt vmcnt(20)
  v_mfma_f32_16x16x32_bf16 v[52:55], v[96:99], a[132:135], v[52:55]
  ds_read_b128 v[96:99], v15 offset:36864
  v_permlane32_swap_b32 v240, v242
  v_mfma_f32_16x16x32_bf16 v[56:59], v[100:103], a[128:131], v[56:59]
  v_mov_b32 v46, 2
  v_mov_b32 v44, 3
  v_mfma_f32_16x16x32_bf16 v[60:63], v[100:103], a[132:135], v[60:63]
  ds_read_b128 v[100:103], v15 offset:37888
  v_mfma_f32_16x16x32_bf16 v[64:67], v[104:107], a[128:131], v[64:67]
  buffer_load_dwordx4 v3, s[24:27], s20 offen offset:3072 sc1 lds
  s_add_u32 m0, s19, 65536
  s_add_u32 s20, s18, 45056
  v_mfma_f32_16x16x32_bf16 v[68:71], v[104:107], a[132:135], v[68:71]
  ds_read_b128 v[104:107], v15 offset:38912
  v_mfma_f32_16x16x32_bf16 v[72:75], v[108:111], a[128:131], v[72:75]
  v_mfma_f32_16x16x32_bf16 v[76:79], v[108:111], a[132:135], v[76:79]
  ds_read_b128 v[108:111], v15 offset:39936
  s_waitcnt vmcnt(20) lgkmcnt(12)
  v_mfma_f32_16x16x32_bf16 v[48:51], v[112:115], a[136:139], v[48:51]
  buffer_load_dwordx4 v3, s[24:27], s20 offen sc1 lds
  s_add_u32 m0, s19, 0
  s_add_u32 s20, s18, 61440
  s_waitcnt vmcnt(20)
  v_mfma_f32_16x16x32_bf16 v[52:55], v[112:115], a[140:143], v[52:55]
  ds_read_b128 v[112:115], v15 offset:40960
  v_mfma_f32_16x16x32_bf16 v[56:59], v[116:119], a[136:139], v[56:59]
  v_mfma_f32_16x16x32_bf16 v[60:63], v[116:119], a[140:143], v[60:63]
  ds_read_b128 v[116:119], v15 offset:41984
  v_mfma_f32_16x16x32_bf16 v[64:67], v[120:123], a[136:139], v[64:67]
  buffer_load_dwordx4 v3, s[24:27], s20 offen offset:0 sc1 lds
  v_mfma_f32_16x16x32_bf16 v[68:71], v[120:123], a[140:143], v[68:71]
  ds_read_b128 v[120:123], v15 offset:43008
  v_mfma_f32_16x16x32_bf16 v[72:75], v[124:127], a[136:139], v[72:75]
  v_mfma_f32_16x16x32_bf16 v[76:79], v[124:127], a[140:143], v[76:79]
  ds_read_b128 v[124:127], v15 offset:44032
  s_waitcnt vmcnt(20) lgkmcnt(12)
  v_mfma_f32_16x16x32_bf16 v[48:51], v[128:131], a[144:147], v[48:51]
  buffer_load_dwordx4 v3, s[24:27], s20 offen offset:1024 sc1 lds
  s_waitcnt vmcnt(20)
  v_mfma_f32_16x16x32_bf16 v[52:55], v[128:131], a[148:151], v[52:55]
  ds_read_b128 v[128:131], v15 offset:45056
  v_mfma_f32_16x16x32_bf16 v[56:59], v[132:135], a[144:147], v[56:59]
  v_mfma_f32_16x16x32_bf16 v[60:63], v[132:135], a[148:151], v[60:63]
  ds_read_b128 v[132:135], v15 offset:46080
  v_mfma_f32_16x16x32_bf16 v[64:67], v[136:139], a[144:147], v[64:67]
  buffer_load_dwordx4 v3, s[24:27], s20 offen offset:2048 sc1 lds
  v_mfma_f32_16x16x32_bf16 v[68:71], v[136:139], a[148:151], v[68:71]
  ds_read_b128 v[136:139], v15 offset:47104
  v_mfma_f32_16x16x32_bf16 v[72:75], v[140:143], a[144:147], v[72:75]
  v_mfma_f32_16x16x32_bf16 v[76:79], v[140:143], a[148:151], v[76:79]
  ds_read_b128 v[140:143], v15 offset:48128
  s_waitcnt vmcnt(20) lgkmcnt(12)
  v_mfma_f32_16x16x32_bf16 v[48:51], v[144:147], a[152:155], v[48:51]
  buffer_load_dwordx4 v3, s[24:27], s20 offen offset:3072 sc1 lds
  s_add_u32 m0, s19, 4096
  s_add_u32 s20, s18, 65536
  s_waitcnt vmcnt(20)
  v_mfma_f32_16x16x32_bf16 v[52:55], v[144:147], a[156:159], v[52:55]
  ds_read_b128 v[144:147], v15 offset:49152
  v_mfma_f32_16x16x32_bf16 v[56:59], v[148:151], a[152:155], v[56:59]
  s_nop 0
  v_fma_f32 v48, -v160, v214, v48
  v_fma_f32 v49, -v161, v214, v49
  v_mfma_f32_16x16x32_bf16 v[60:63], v[148:151], a[156:159], v[60:63]
  ds_read_b128 v[148:151], v15 offset:50176
  v_fma_f32 v50, -v162, v214, v50
  v_mfma_f32_16x16x32_bf16 v[64:67], v[152:155], a[152:155], v[64:67]
  buffer_load_dwordx4 v3, s[24:27], s20 offen sc1 lds
  s_add_u32 m0, s19, 20480
  s_add_u32 s20, s18, 81920
  v_mfma_f32_16x16x32_bf16 v[68:71], v[152:155], a[156:159], v[68:71]
  ds_read_b128 v[152:155], v15 offset:51200
  v_fma_f32 v51, -v163, v214, v51
  v_mfma_f32_16x16x32_bf16 v[72:75], v[156:159], a[152:155], v[72:75]
  v_mul_f32 v228, v48, v48
  v_mul_f32 v229, v49, v49
  v_mfma_f32_16x16x32_bf16 v[76:79], v[156:159], a[156:159], v[76:79]
  ds_read_b128 v[156:159], v15 offset:52224
  v_mul_f32 v230, v50, v50
  s_waitcnt lgkmcnt(12)
  v_mfma_f32_16x16x32_bf16 v[80:83], v[96:99], a[0:3], 0
  buffer_load_dwordx4 v3, s[24:27], s20 offen offset:0 sc1 lds
  v_mul_f32 v231, v51, v51
  v_mfma_f32_16x16x32_bf16 v[84:87], v[96:99], a[4:7], 0
  ds_read_b128 v[96:99], v15 offset:53248
  v_fma_f32 v228, v228, v224, v210
  v_mfma_f32_16x16x32_bf16 v[88:91], v[100:103], a[0:3], 0
  v_fma_f32 v229, v229, v224, v210
  v_fma_f32 v230, v230, v224, v210
  v_mfma_f32_16x16x32_bf16 v[92:95], v[100:103], a[4:7], 0
  ds_read_b128 v[100:103], v15 offset:54272
  v_fma_f32 v231, v231, v224, v210
  v_mfma_f32_16x16x32_bf16 v[80:83], v[104:107], a[8:11], v[80:83]
  buffer_load_dwordx4 v3, s[24:27], s20 offen offset:1024 sc1 lds
  v_mul_f32 v228, v228, v48
  v_mfma_f32_16x16x32_bf16 v[84:87], v[104:107], a[12:15], v[84:87]
  ds_read_b128 v[104:107], v15 offset:55296
  v_mul_f32 v229, v229, v49
  v_mfma_f32_16x16x32_bf16 v[88:91], v[108:111], a[8:11], v[88:91]
  v_mul_f32 v230, v230, v50
  v_mul_f32 v231, v231, v51
  v_mfma_f32_16x16x32_bf16 v[92:95], v[108:111], a[12:15], v[92:95]
  ds_read_b128 v[108:111], v15 offset:56320
  v_exp_f32 v228, v228
  s_waitcnt lgkmcnt(12)
  v_mfma_f32_16x16x32_bf16 v[80:83], v[112:115], a[16:19], v[80:83]
  buffer_load_dwordx4 v3, s[24:27], s20 offen offset:2048 sc1 lds
  v_exp_f32 v229, v229
  v_mfma_f32_16x16x32_bf16 v[84:87], v[112:115], a[20:23], v[84:87]
  ds_read_b128 v[112:115], v15 offset:57344
  v_exp_f32 v230, v230
  v_mfma_f32_16x16x32_bf16 v[88:91], v[116:119], a[16:19], v[88:91]
  v_exp_f32 v231, v231
  v_mfma_f32_16x16x32_bf16 v[92:95], v[116:119], a[20:23], v[92:95]
  ds_read_b128 v[116:119], v15 offset:58368
  v_fma_f32 v228, v228, v240, v240
  buffer_load_dwordx4 v3, s[24:27], s20 offen offset:3072 sc1 lds
  s_add_u32 m0, s19, 24576
  s_add_u32 s20, s18, 86016
  s_lshl_b32 s32, s47, 10
  s_add_u32 s40, s40, s32
  s_add_u32 s43, s40, s13
  s_add_u32 s44, s43, 61440
  s_add_u32 s11, s11, 16384
  s_and_b32 s33, s3, 1
  s_lshl_b32 s32, s33, 11
  s_add_u32 s32, s32, s13
  s_add_u32 s36, s36, s32
  s_xor_b32 s37, s28, 1
  s_mul_i32 s33, s33, 10240
  s_mul_i32 s37, s37, 61440
  s_add_u32 s37, s37, s32
  buffer_load_dwordx4 v3, s[24:27], s20 offen sc1 lds
  v_mfma_f32_16x16x32_bf16 v[80:83], v[120:123], a[24:27], v[80:83]
  v_add_u32 v40, s33, v3
  v_add_u32 v41, s33, v15
  v_mfma_f32_16x16x32_bf16 v[84:87], v[120:123], a[28:31], v[84:87]
  ds_read_b128 v[120:123], v15 offset:59392
  v_add_u32 v42, s33, v16
  s_xor_b32 s33, s3, 1
  s_sub_u32 s14, s11, 37069312
  s_mul_i32 s33, s33, 5120
  s_lshl_b32 s14, s14, 1
  s_add_u32 s14, s14, 37073408
  v_mfma_f32_16x16x32_bf16 v[88:91], v[124:127], a[24:27], v[88:91]
  v_add_u32 v43, s33, v3
  s_lshl_b32 s33, s3, 4
  s_add_u32 s33, s33, s47
  s_lshl_b32 s33, s33, 2
  s_add_u32 s15, s14, s33
  s_and_b32 s33, s28, 6
  s_lshl_b32 s33, s33, 5
  s_add_u32 s14, s14, s33
  s_add_u32 s20, s18, 163840
  buffer_load_dwordx4 a[160:163], v3, s[24:27], s20 offen offset:0 sc1
  v_mfma_f32_16x16x32_bf16 v[92:95], v[124:127], a[28:31], v[92:95]
  ds_read_b128 v[124:127], v15 offset:60416
  v_fma_f32 v229, v229, v240, v240
  s_waitcnt lgkmcnt(12)
  v_mfma_f32_16x16x32_bf16 v[80:83], v[128:131], a[32:35], v[80:83]
  v_fma_f32 v230, v230, v240, v240
  v_fma_f32 v231, v231, v240, v240
  v_mfma_f32_16x16x32_bf16 v[84:87], v[128:131], a[36:39], v[84:87]
  ds_read_b128 v[128:131], v15 offset:61440
  v_rcp_f32 v228, v228
  v_mfma_f32_16x16x32_bf16 v[88:91], v[132:135], a[32:35], v[88:91]
  buffer_load_dwordx4 a[164:167], v3, s[24:27], s20 offen offset:1024 sc1
  v_rcp_f32 v229, v229
  v_mfma_f32_16x16x32_bf16 v[92:95], v[132:135], a[36:39], v[92:95]
  ds_read_b128 v[132:135], v15 offset:62464
  v_rcp_f32 v230, v230
  v_mfma_f32_16x16x32_bf16 v[80:83], v[136:139], a[40:43], v[80:83]
  v_rcp_f32 v231, v231
  v_mfma_f32_16x16x32_bf16 v[84:87], v[136:139], a[44:47], v[84:87]
  ds_read_b128 v[136:139], v15 offset:63488
  v_fma_f32 v56, -v164, v214, v56
  buffer_load_dwordx4 a[168:171], v3, s[24:27], s20 offen offset:2048 sc1
  v_mfma_f32_16x16x32_bf16 v[88:91], v[140:143], a[40:43], v[88:91]
  v_fma_f32 v57, -v165, v214, v57
  v_fma_f32 v58, -v166, v214, v58
  v_mfma_f32_16x16x32_bf16 v[92:95], v[140:143], a[44:47], v[92:95]
  ds_read_b128 v[140:143], v15 offset:64512
  v_fma_f32 v59, -v167, v214, v59
  s_waitcnt lgkmcnt(12)
  v_mfma_f32_16x16x32_bf16 v[80:83], v[144:147], a[48:51], v[80:83]
  v_mul_f32 v232, v56, v56
  v_mul_f32 v233, v57, v57
  v_mfma_f32_16x16x32_bf16 v[84:87], v[144:147], a[52:55], v[84:87]
  ds_read_b128 v[144:147], v16 offset:0
  buffer_load_dwordx4 a[172:175], v3, s[24:27], s20 offen offset:3072 sc1
  s_add_u32 s20, s18, 167936
  v_mfma_f32_16x16x32_bf16 v[88:91], v[148:151], a[48:51], v[88:91]
  v_mul_f32 v234, v58, v58
  v_mul_f32 v235, v59, v59
  v_mfma_f32_16x16x32_bf16 v[92:95], v[148:151], a[52:55], v[92:95]
  ds_read_b128 v[148:151], v16 offset:1024
  v_mul_f32 v48, v48, v228
  v_mfma_f32_16x16x32_bf16 v[80:83], v[152:155], a[56:59], v[80:83]
  v_mul_f32 v49, v49, v229
  v_mul_f32 v50, v50, v230
  v_mfma_f32_16x16x32_bf16 v[84:87], v[152:155], a[60:63], v[84:87]
  buffer_load_dwordx4 a[176:179], v3, s[24:27], s20 offen offset:0 sc1
  s_add_u32 s20, s18, 184320
  v_mfma_f32_16x16x32_bf16 v[88:91], v[156:159], a[56:59], v[88:91]
  ds_read_b128 v[152:155], v16 offset:2048
  v_mul_f32 v51, v51, v231
  v_mfma_f32_16x16x32_bf16 v[92:95], v[156:159], a[60:63], v[92:95]
  ds_read_b128 v[156:159], v16 offset:3072
  v_fma_f32 v52, -v160, v216, v52
  s_waitcnt lgkmcnt(12)
  v_mfma_f32_16x16x32_bf16 v[80:83], v[96:99], a[64:67], v[80:83]
  v_fma_f32 v53, -v161, v216, v53
  v_fma_f32 v54, -v162, v216, v54
  v_mfma_f32_16x16x32_bf16 v[84:87], v[96:99], a[68:71], v[84:87]
  buffer_load_dwordx4 a[180:183], v3, s[24:27], s20 offen offset:0 sc1
  ds_read_b128 v[96:99], v16 offset:4096
  v_mfma_f32_16x16x32_bf16 v[88:91], v[100:103], a[64:67], v[88:91]
  v_fma_f32 v55, -v163, v216, v55
  v_fma_f32 v60, -v164, v216, v60
  v_mfma_f32_16x16x32_bf16 v[92:95], v[100:103], a[68:71], v[92:95]
  ds_read_b128 v[100:103], v16 offset:5120
  v_fma_f32 v61, -v165, v216, v61
  v_mfma_f32_16x16x32_bf16 v[80:83], v[104:107], a[72:75], v[80:83]
  v_fma_f32 v62, -v166, v216, v62
  v_fma_f32 v63, -v167, v216, v63
  v_mfma_f32_16x16x32_bf16 v[84:87], v[104:107], a[76:79], v[84:87]
  buffer_load_dwordx4 a[184:187], v3, s[24:27], s20 offen offset:1024 sc1
  ds_read_b128 v[104:107], v16 offset:6144
  v_mfma_f32_16x16x32_bf16 v[88:91], v[108:111], a[72:75], v[88:91]
  v_fma_f32 v232, v232, v224, v210
  v_fma_f32 v233, v233, v224, v210
  v_mfma_f32_16x16x32_bf16 v[92:95], v[108:111], a[76:79], v[92:95]
  ds_read_b128 v[108:111], v16 offset:7168
  v_fma_f32 v234, v234, v224, v210
  s_waitcnt lgkmcnt(12)
  v_mfma_f32_16x16x32_bf16 v[80:83], v[112:115], a[80:83], v[80:83]
  v_fma_f32 v235, v235, v224, v210
  v_mul_f32 v236, v52, v52
  v_mfma_f32_16x16x32_bf16 v[84:87], v[112:115], a[84:87], v[84:87]
  buffer_load_dwordx4 a[188:191], v3, s[24:27], s20 offen offset:2048 sc1
  ds_read_b128 v[112:115], v16 offset:8192
  v_mfma_f32_16x16x32_bf16 v[88:91], v[116:119], a[80:83], v[88:91]
  v_mul_f32 v237, v53, v53
  v_mul_f32 v238, v54, v54
  v_mfma_f32_16x16x32_bf16 v[92:95], v[116:119], a[84:87], v[92:95]
  ds_read_b128 v[116:119], v16 offset:9216
  v_mul_f32 v239, v55, v55
  v_mfma_f32_16x16x32_bf16 v[80:83], v[120:123], a[88:91], v[80:83]
  v_mul_f32 v228, v60, v60
  v_mul_f32 v229, v61, v61
  v_mfma_f32_16x16x32_bf16 v[84:87], v[120:123], a[92:95], v[84:87]
  buffer_load_dwordx4 a[192:195], v3, s[24:27], s20 offen offset:3072 sc1
  s_add_u32 s20, s18, 188416
  v_mfma_f32_16x16x32_bf16 v[88:91], v[124:127], a[88:91], v[88:91]
  ds_read_b128 v[120:123], v16 offset:10240
  v_mul_f32 v230, v62, v62
  v_mfma_f32_16x16x32_bf16 v[92:95], v[124:127], a[92:95], v[92:95]
  ds_read_b128 v[124:127], v16 offset:11264
  v_mul_f32 v231, v63, v63
  s_waitcnt lgkmcnt(12)
  v_mfma_f32_16x16x32_bf16 v[80:83], v[128:131], a[96:99], v[80:83]
  v_mul_f32 v232, v232, v56
  v_mul_f32 v233, v233, v57
  v_mfma_f32_16x16x32_bf16 v[84:87], v[128:131], a[100:103], v[84:87]
  buffer_load_dwordx4 a[196:199], v3, s[24:27], s20 offen offset:0 sc1
  v_mul_f32 v234, v234, v58
  v_mfma_f32_16x16x32_bf16 v[88:91], v[132:135], a[96:99], v[88:91]
  v_mul_f32 v235, v235, v59
  v_fma_f32 v236, v236, v226, v212
  v_mfma_f32_16x16x32_bf16 v[92:95], v[132:135], a[100:103], v[92:95]
  v_fma_f32 v237, v237, v226, v212
  v_fma_f32 v238, v238, v226, v212
  v_fma_f32 v239, v239, v226, v212
  v_fma_f32 v228, v228, v226, v212
  v_fma_f32 v229, v229, v226, v212
  v_fma_f32 v230, v230, v226, v212
  v_fma_f32 v231, v231, v226, v212
  v_exp_f32 v232, v232
  v_exp_f32 v233, v233
  v_exp_f32 v234, v234
  v_exp_f32 v235, v235
  v_mul_f32 v236, v236, v52
  v_mul_f32 v237, v237, v53
  v_mul_f32 v238, v238, v54
  v_mul_f32 v239, v239, v55
  v_mul_f32 v228, v228, v60
  v_mul_f32 v229, v229, v61
  v_mul_f32 v230, v230, v62
  v_mul_f32 v231, v231, v63
  v_exp_f32 v236, v236
  v_exp_f32 v237, v237
  v_exp_f32 v238, v238
  v_exp_f32 v239, v239
  v_exp_f32 v228, v228
  v_exp_f32 v229, v229
  v_exp_f32 v230, v230
  v_exp_f32 v231, v231
  v_mfma_f32_16x16x32_bf16 v[80:83], v[136:139], a[104:107], v[80:83]
  v_fma_f32 v232, v232, v240, v240
  v_fma_f32 v233, v233, v240, v240
  v_mfma_f32_16x16x32_bf16 v[84:87], v[136:139], a[108:111], v[84:87]
  v_fma_f32 v234, v234, v240, v240
  v_fma_f32 v235, v235, v240, v240
  v_mfma_f32_16x16x32_bf16 v[88:91], v[140:143], a[104:107], v[88:91]
  v_rcp_f32 v232, v232
  v_mfma_f32_16x16x32_bf16 v[92:95], v[140:143], a[108:111], v[92:95]
  v_rcp_f32 v233, v233
  v_rcp_f32 v234, v234
  v_rcp_f32 v235, v235
  v_fma_f32 v236, v236, v242, v242
  v_fma_f32 v237, v237, v242, v242
  v_fma_f32 v238, v238, v242, v242
  v_fma_f32 v239, v239, v242, v242
  v_fma_f32 v228, v228, v242, v242
  v_fma_f32 v229, v229, v242, v242
  v_fma_f32 v230, v230, v242, v242
  v_fma_f32 v231, v231, v242, v242
  v_rcp_f32 v236, v236
  v_rcp_f32 v237, v237
  v_rcp_f32 v238, v238
  v_rcp_f32 v239, v239
  v_rcp_f32 v228, v228
  v_rcp_f32 v229, v229
  v_rcp_f32 v230, v230
  v_rcp_f32 v231, v231
  v_mul_f32 v56, v56, v232
  v_mul_f32 v57, v57, v233
  v_mul_f32 v58, v58, v234
  v_mul_f32 v59, v59, v235
  v_fma_f32 v64, -v168, v214, v64
  v_fma_f32 v65, -v169, v214, v65
  v_fma_f32 v66, -v170, v214, v66
  v_fma_f32 v67, -v171, v214, v67
  s_waitcnt lgkmcnt(8)
  v_mfma_f32_16x16x32_bf16 v[80:83], v[144:147], a[112:115], v[80:83]
  v_mul_f32 v232, v64, v64
  v_mul_f32 v233, v65, v65
  v_mfma_f32_16x16x32_bf16 v[84:87], v[144:147], a[116:119], v[84:87]
  v_mul_f32 v234, v66, v66
  v_mul_f32 v235, v67, v67
  v_mfma_f32_16x16x32_bf16 v[88:91], v[148:151], a[112:115], v[88:91]
  v_mul_f32 v52, v52, v236
  v_mul_f32 v53, v53, v237
  v_mfma_f32_16x16x32_bf16 v[92:95], v[148:151], a[116:119], v[92:95]
  v_mul_f32 v54, v54, v238
  v_mul_f32 v55, v55, v239
  v_mul_f32 v60, v60, v228
  v_mul_f32 v61, v61, v229
  v_mul_f32 v62, v62, v230
  v_mul_f32 v63, v63, v231
  v_cvt_pk_bf16_f32 v184, v48, v56
  v_cvt_pk_bf16_f32 v185, v49, v57
  v_cvt_pk_bf16_f32 v186, v50, v58
  v_cvt_pk_bf16_f32 v187, v51, v59
  buffer_store_dwordx4 v[184:187], v3, s[24:27], s43 offen sc1
  s_add_u32 s43, s43, 16384
  v_fma_f32 v232, v232, v224, v210
  v_fma_f32 v233, v233, v224, v210
  v_fma_f32 v234, v234, v224, v210
  v_fma_f32 v235, v235, v224, v210
  v_cvt_pk_bf16_f32 v196, v52, v60
  v_cvt_pk_bf16_f32 v197, v53, v61
  v_cvt_pk_bf16_f32 v198, v54, v62
  v_cvt_pk_bf16_f32 v199, v55, v63
  v_mul_f32 v232, v232, v64
  v_mul_f32 v233, v233, v65
  v_mul_f32 v234, v234, v66
  v_mul_f32 v235, v235, v67
  v_exp_f32 v232, v232
  buffer_store_dwordx4 v[196:199], v3, s[24:27], s44 offen sc1
  s_add_u32 s44, s44, 16384
  s_add_u32 s20, s18, 204800
  v_exp_f32 v233, v233
  v_exp_f32 v234, v234
  v_exp_f32 v235, v235
  v_mfma_f32_16x16x32_bf16 v[80:83], v[152:155], a[120:123], v[80:83]
  v_fma_f32 v232, v232, v240, v240
  v_fma_f32 v233, v233, v240, v240
  v_mfma_f32_16x16x32_bf16 v[84:87], v[152:155], a[124:127], v[84:87]
  v_fma_f32 v234, v234, v240, v240
  buffer_load_dwordx4 a[200:203], v3, s[24:27], s20 offen offset:0 sc1
  v_mfma_f32_16x16x32_bf16 v[88:91], v[156:159], a[120:123], v[88:91]
  v_fma_f32 v235, v235, v240, v240
  v_rcp_f32 v232, v232
  v_mfma_f32_16x16x32_bf16 v[92:95], v[156:159], a[124:127], v[92:95]
  v_rcp_f32 v233, v233
  v_rcp_f32 v234, v234
  v_rcp_f32 v235, v235
  v_fma_f32 v72, -v172, v214, v72
  v_fma_f32 v73, -v173, v214, v73
  buffer_load_dwordx4 a[204:207], v3, s[24:27], s20 offen offset:1024 sc1
  v_fma_f32 v74, -v174, v214, v74
  v_fma_f32 v75, -v175, v214, v75
  s_waitcnt lgkmcnt(7)
  v_mfma_f32_16x16x32_bf16 v[80:83], v[96:99], a[128:131], v[80:83]
  v_mul_f32 v64, v64, v232
  v_mul_f32 v65, v65, v233
  v_mfma_f32_16x16x32_bf16 v[84:87], v[96:99], a[132:135], v[84:87]
  v_mul_f32 v66, v66, v234
  v_mul_f32 v67, v67, v235
  s_waitcnt lgkmcnt(6)
  v_mfma_f32_16x16x32_bf16 v[88:91], v[100:103], a[128:131], v[88:91]
  v_fma_f32 v68, -v168, v216, v68
  v_fma_f32 v69, -v169, v216, v69
  v_mfma_f32_16x16x32_bf16 v[92:95], v[100:103], a[132:135], v[92:95]
  buffer_load_dwordx4 a[208:211], v3, s[24:27], s20 offen offset:2048 sc1
  v_fma_f32 v70, -v170, v216, v70
  v_fma_f32 v71, -v171, v216, v71
  v_fma_f32 v76, -v172, v216, v76
  v_fma_f32 v77, -v173, v216, v77
  v_fma_f32 v78, -v174, v216, v78
  v_fma_f32 v79, -v175, v216, v79
  v_mul_f32 v236, v72, v72
  v_mul_f32 v237, v73, v73
  v_mul_f32 v238, v74, v74
  v_mul_f32 v239, v75, v75
  v_mul_f32 v228, v68, v68
  v_mul_f32 v229, v69, v69
  v_mul_f32 v230, v70, v70
  v_mul_f32 v231, v71, v71
  buffer_load_dwordx4 a[212:215], v3, s[24:27], s20 offen offset:3072 sc1
  s_add_u32 s20, s18, 208896
  v_mul_f32 v232, v76, v76
  v_mul_f32 v233, v77, v77
  v_mul_f32 v234, v78, v78
  v_mul_f32 v235, v79, v79
  v_fma_f32 v236, v236, v224, v210
  v_fma_f32 v237, v237, v224, v210
  v_fma_f32 v238, v238, v224, v210
  v_fma_f32 v239, v239, v224, v210
  v_fma_f32 v228, v228, v226, v212
  v_fma_f32 v229, v229, v226, v212
  v_fma_f32 v230, v230, v226, v212
  v_fma_f32 v231, v231, v226, v212
  v_fma_f32 v232, v232, v226, v212
  buffer_load_dwordx4 a[216:219], v3, s[24:27], s20 offen offset:0 sc1
  s_add_u32 s20, s18, 225280
  v_fma_f32 v233, v233, v226, v212
  v_fma_f32 v234, v234, v226, v212
  v_fma_f32 v235, v235, v226, v212
  v_mul_f32 v236, v236, v72
  v_mul_f32 v237, v237, v73
  v_mul_f32 v238, v238, v74
  v_mul_f32 v239, v239, v75
  v_mul_f32 v228, v228, v68
  v_mul_f32 v229, v229, v69
  v_mul_f32 v230, v230, v70
  v_mul_f32 v231, v231, v71
  v_mul_f32 v232, v232, v76
  v_mul_f32 v233, v233, v77
  buffer_load_dwordx4 a[220:223], v3, s[24:27], s20 offen offset:0 sc1
  v_mul_f32 v234, v234, v78
  v_mul_f32 v235, v235, v79
  v_exp_f32 v236, v236
  v_exp_f32 v237, v237
  v_exp_f32 v238, v238
  v_exp_f32 v239, v239
  s_waitcnt lgkmcnt(5)
  v_mfma_f32_16x16x32_bf16 v[80:83], v[104:107], a[136:139], v[80:83]
  v_exp_f32 v228, v228
  v_mfma_f32_16x16x32_bf16 v[84:87], v[104:107], a[140:143], v[84:87]
  buffer_load_dwordx4 a[224:227], v3, s[24:27], s20 offen offset:1024 sc1
  v_exp_f32 v229, v229
  s_waitcnt lgkmcnt(4)
  v_mfma_f32_16x16x32_bf16 v[88:91], v[108:111], a[136:139], v[88:91]
  v_exp_f32 v230, v230
  v_mfma_f32_16x16x32_bf16 v[92:95], v[108:111], a[140:143], v[92:95]
  v_exp_f32 v231, v231
  v_exp_f32 v232, v232
  v_exp_f32 v233, v233
  v_exp_f32 v234, v234
  buffer_load_dwordx4 a[228:231], v3, s[24:27], s20 offen offset:2048 sc1
  v_exp_f32 v235, v235
  v_fma_f32 v236, v236, v240, v240
  v_fma_f32 v237, v237, v240, v240
  v_fma_f32 v238, v238, v240, v240
  v_fma_f32 v239, v239, v240, v240
  v_fma_f32 v228, v228, v242, v242
  v_fma_f32 v229, v229, v242, v242
  v_fma_f32 v230, v230, v242, v242
  v_fma_f32 v231, v231, v242, v242
  v_fma_f32 v232, v232, v242, v242
  v_fma_f32 v233, v233, v242, v242
  v_fma_f32 v234, v234, v242, v242
  v_fma_f32 v235, v235, v242, v242
  buffer_load_dwordx4 a[232:235], v3, s[24:27], s20 offen offset:3072 sc1
  s_add_u32 s20, s18, 229376
  v_rcp_f32 v236, v236
  v_rcp_f32 v237, v237
  v_rcp_f32 v238, v238
  v_rcp_f32 v239, v239
  v_rcp_f32 v228, v228
  v_rcp_f32 v229, v229
  v_rcp_f32 v230, v230
  buffer_load_dwordx4 a[236:239], v3, s[24:27], s20 offen offset:0 sc1
  v_rcp_f32 v231, v231
  v_rcp_f32 v232, v232
  v_rcp_f32 v233, v233
  v_rcp_f32 v234, v234
  v_rcp_f32 v235, v235
  s_waitcnt lgkmcnt(3)
  v_mfma_f32_16x16x32_bf16 v[80:83], v[112:115], a[144:147], v[80:83]
  v_mul_f32 v72, v72, v236
  v_mul_f32 v73, v73, v237
  v_mfma_f32_16x16x32_bf16 v[84:87], v[112:115], a[148:151], v[84:87]
  v_mul_f32 v74, v74, v238
  v_mul_f32 v75, v75, v239
  s_waitcnt lgkmcnt(2)
  v_mfma_f32_16x16x32_bf16 v[88:91], v[116:119], a[144:147], v[88:91]
  v_mul_f32 v68, v68, v228
  v_mul_f32 v69, v69, v229
  v_mfma_f32_16x16x32_bf16 v[92:95], v[116:119], a[148:151], v[92:95]
  v_mul_f32 v70, v70, v230
  v_mul_f32 v71, v71, v231
  v_mul_f32 v76, v76, v232
  v_mul_f32 v77, v77, v233
  v_mul_f32 v78, v78, v234
  v_mul_f32 v79, v79, v235
  v_cvt_pk_bf16_f32 v188, v64, v72
  v_cvt_pk_bf16_f32 v189, v65, v73
  v_cvt_pk_bf16_f32 v190, v66, v74
  v_cvt_pk_bf16_f32 v191, v67, v75
  buffer_store_dwordx4 v[188:191], v3, s[24:27], s43 offen sc1
  v_cvt_pk_bf16_f32 v200, v68, v76
  v_cvt_pk_bf16_f32 v201, v69, v77
  v_cvt_pk_bf16_f32 v202, v70, v78
  v_cvt_pk_bf16_f32 v203, v71, v79
  s_waitcnt lgkmcnt(1)
  v_mfma_f32_16x16x32_bf16 v[80:83], v[120:123], a[152:155], v[80:83]
  s_add_u32 s43, s43, 16384
  v_mfma_f32_16x16x32_bf16 v[84:87], v[120:123], a[156:159], v[84:87]
  s_waitcnt lgkmcnt(0)
  v_mfma_f32_16x16x32_bf16 v[88:91], v[124:127], a[152:155], v[88:91]
  buffer_store_dwordx4 v[200:203], v3, s[24:27], s44 offen sc1
  v_mfma_f32_16x16x32_bf16 v[92:95], v[124:127], a[156:159], v[92:95]
  s_add_u32 s44, s44, 16384
  s_barrier
  s_waitcnt vmcnt(12)
  s_add_u32 m0, s19, 81920
  buffer_store_dword v9, v45, s[24:27], s15 offen
  s_add_u32 s20, s18, 102400
  v_pk_fma_f32 v[80:81], v[176:177], v[214:215], v[80:81] op_sel_hi:[1,0,1] neg_lo:[1,0,0] neg_hi:[1,0,0]
  v_pk_fma_f32 v[82:83], v[178:179], v[214:215], v[82:83] op_sel_hi:[1,0,1] neg_lo:[1,0,0] neg_hi:[1,0,0]
  v_pk_mul_f32 v[236:237], v[80:81], v[80:81]
  v_pk_mul_f32 v[238:239], v[82:83], v[82:83]
  v_pk_fma_f32 v[236:237], v[236:237], v[224:225], v[210:211] op_sel_hi:[1,0,0]
  v_pk_fma_f32 v[238:239], v[238:239], v[224:225], v[210:211] op_sel_hi:[1,0,0]
  buffer_load_dwordx4 v3, s[24:27], s20 offen offset:0 sc1 lds
  v_pk_mul_f32 v[236:237], v[236:237], v[80:81]
  v_pk_mul_f32 v[238:239], v[238:239], v[82:83]
  v_exp_f32 v236, v236
  v_exp_f32 v237, v237
  v_exp_f32 v238, v238
  v_exp_f32 v239, v239
  v_pk_fma_f32 v[236:237], v[236:237], v[240:241], v[240:241] op_sel_hi:[1,0,0]
  v_pk_fma_f32 v[238:239], v[238:239], v[240:241], v[240:241] op_sel_hi:[1,0,0]
  v_pk_fma_f32 v[88:89], v[180:181], v[214:215], v[88:89] op_sel_hi:[1,0,1] neg_lo:[1,0,0] neg_hi:[1,0,0]
  v_pk_fma_f32 v[90:91], v[182:183], v[214:215], v[90:91] op_sel_hi:[1,0,1] neg_lo:[1,0,0] neg_hi:[1,0,0]
  v_rcp_f32 v236, v236
  buffer_load_dwordx4 v3, s[24:27], s20 offen offset:1024 sc1 lds
  v_rcp_f32 v237, v237
  v_rcp_f32 v238, v238
  v_rcp_f32 v239, v239
  v_pk_mul_f32 v[228:229], v[88:89], v[88:89]
  v_pk_mul_f32 v[230:231], v[90:91], v[90:91]
  v_pk_mul_f32 v[80:81], v[80:81], v[236:237]
  v_pk_mul_f32 v[82:83], v[82:83], v[238:239]
  v_pk_fma_f32 v[84:85], v[176:177], v[216:217], v[84:85] op_sel_hi:[1,0,1] neg_lo:[1,0,0] neg_hi:[1,0,0]
  v_pk_fma_f32 v[86:87], v[178:179], v[216:217], v[86:87] op_sel_hi:[1,0,1] neg_lo:[1,0,0] neg_hi:[1,0,0]
  v_pk_fma_f32 v[92:93], v[180:181], v[216:217], v[92:93] op_sel_hi:[1,0,1] neg_lo:[1,0,0] neg_hi:[1,0,0]
  v_pk_fma_f32 v[94:95], v[182:183], v[216:217], v[94:95] op_sel_hi:[1,0,1] neg_lo:[1,0,0] neg_hi:[1,0,0]
  v_pk_fma_f32 v[228:229], v[228:229], v[224:225], v[210:211] op_sel_hi:[1,0,0]
  buffer_load_dwordx4 v3, s[24:27], s20 offen offset:2048 sc1 lds
  v_pk_fma_f32 v[230:231], v[230:231], v[224:225], v[210:211] op_sel_hi:[1,0,0]
  v_pk_mul_f32 v[232:233], v[84:85], v[84:85]
  v_pk_mul_f32 v[234:235], v[86:87], v[86:87]
  v_pk_mul_f32 v[236:237], v[92:93], v[92:93]
  v_pk_mul_f32 v[238:239], v[94:95], v[94:95]
  v_pk_mul_f32 v[228:229], v[228:229], v[88:89]
  v_pk_mul_f32 v[230:231], v[230:231], v[90:91]
  v_pk_fma_f32 v[232:233], v[232:233], v[226:227], v[212:213] op_sel_hi:[1,0,0]
  v_pk_fma_f32 v[234:235], v[234:235], v[226:227], v[212:213] op_sel_hi:[1,0,0]
  v_pk_fma_f32 v[236:237], v[236:237], v[226:227], v[212:213] op_sel_hi:[1,0,0]
  v_pk_fma_f32 v[238:239], v[238:239], v[226:227], v[212:213] op_sel_hi:[1,0,0]
  v_exp_f32 v228, v228
  v_exp_f32 v229, v229
  buffer_load_dwordx4 v3, s[24:27], s20 offen offset:3072 sc1 lds
  s_add_u32 m0, s19, 86016
  s_add_u32 s20, s18, 106496
  v_exp_f32 v230, v230
  v_exp_f32 v231, v231
  v_pk_mul_f32 v[232:233], v[232:233], v[84:85]
  v_pk_mul_f32 v[234:235], v[234:235], v[86:87]
  v_pk_mul_f32 v[236:237], v[236:237], v[92:93]
  v_pk_mul_f32 v[238:239], v[238:239], v[94:95]
  v_pk_fma_f32 v[228:229], v[228:229], v[240:241], v[240:241] op_sel_hi:[1,0,0]
  v_pk_fma_f32 v[230:231], v[230:231], v[240:241], v[240:241] op_sel_hi:[1,0,0]
  v_exp_f32 v232, v232
  v_exp_f32 v233, v233
  buffer_load_dwordx4 v3, s[24:27], s20 offen sc1 lds
  v_exp_f32 v234, v234
  v_exp_f32 v235, v235
  v_exp_f32 v236, v236
  v_exp_f32 v237, v237
  v_exp_f32 v238, v238
  v_exp_f32 v239, v239
  v_rcp_f32 v228, v228
  v_rcp_f32 v229, v229
  v_rcp_f32 v230, v230
  v_rcp_f32 v231, v231
  v_pk_fma_f32 v[232:233], v[232:233], v[242:243], v[242:243] op_sel_hi:[1,0,0]
  v_pk_fma_f32 v[234:235], v[234:235], v[242:243], v[242:243] op_sel_hi:[1,0,0]
  v_pk_fma_f32 v[236:237], v[236:237], v[242:243], v[242:243] op_sel_hi:[1,0,0]
  v_pk_fma_f32 v[238:239], v[238:239], v[242:243], v[242:243] op_sel_hi:[1,0,0]
  v_pk_mul_f32 v[88:89], v[88:89], v[228:229]
  v_pk_mul_f32 v[90:91], v[90:91], v[230:231]
  v_rcp_f32 v232, v232
  v_rcp_f32 v233, v233
  v_rcp_f32 v234, v234
  v_rcp_f32 v235, v235
  v_rcp_f32 v236, v236
  v_rcp_f32 v237, v237
  v_rcp_f32 v238, v238
  v_rcp_f32 v239, v239
  v_cvt_pk_bf16_f32 v192, v80, v88
  v_cvt_pk_bf16_f32 v193, v81, v89
  v_cvt_pk_bf16_f32 v194, v82, v90
  v_cvt_pk_bf16_f32 v195, v83, v91
  buffer_store_dwordx4 v[192:195], v3, s[24:27], s43 offen sc1
  v_pk_mul_f32 v[84:85], v[84:85], v[232:233]
  v_pk_mul_f32 v[86:87], v[86:87], v[234:235]
  v_pk_mul_f32 v[92:93], v[92:93], v[236:237]
  v_pk_mul_f32 v[94:95], v[94:95], v[238:239]
  v_cvt_pk_bf16_f32 v204, v84, v92
  v_cvt_pk_bf16_f32 v205, v85, v93
  v_cvt_pk_bf16_f32 v206, v86, v94
  v_cvt_pk_bf16_f32 v207, v87, v95
  s_add_u32 s43, s43, 16384
  buffer_load_dword v11, v10, s[24:27], s14 offen sc1
  buffer_store_dwordx4 v[204:207], v3, s[24:27], s44 offen sc1
  s_add_u32 s44, s44, 16384
  s_waitcnt vmcnt(9)
  buffer_store_dword v46, v45, s[24:27], s15 offen
  s_nop 4
  s_cmp_eq_u32 s56, 0
  s_cbranch_scc1 KM_P6_OUT
  s_waitcnt vmcnt(0)
  s_barrier
  s_cmp_lg_u32 s3, 0
  s_cbranch_scc1 KM_P6_OUT
  s_mov_b64 exec, 1
  s_movk_i32 s22, 0x7fff
  buffer_atomic_add v9, v12, s[24:27], s11 offen sc1
KM_P6:
  v_mov_b32 v7, 0
  buffer_atomic_add v7, v12, s[24:27], s11 offen sc0 sc1
  s_waitcnt vmcnt(0)
  v_cmp_gt_u32 vcc, 16, v7
  s_sub_u32 s22, s22, 1
  s_cbranch_scc1 KM_P6_END
  s_cbranch_vccnz KM_P6
KM_P6_END:
  s_mov_b64 exec, -1
KM_P6_OUT:
  s_nop 4
  s_barrier
  s_waitcnt vmcnt(2)
  v_or_b32 v11, s56, v11
  v_cmp_gt_u32 vcc, 1, v11
  s_nop 4
  s_cbranch_vccz KM_F1_OUT
  s_movk_i32 s22, 0x7fff
KM_F1:
  buffer_load_dword v11, v10, s[24:27], s14 offen sc1
  s_waitcnt vmcnt(0)
  v_cmp_gt_u32 vcc, 1, v11
  s_sub_u32 s22, s22, 1
  s_cbranch_scc1 KM_F1_OUT
  s_cbranch_vccnz KM_F1
KM_F1_OUT:
  s_nop 4
C_P6:
  buffer_load_dwordx4 a[0:3], v3, s[24:27], s36 offen offset:0 sc1
  buffer_load_dwordx4 a[4:7], v3, s[24:27], s37 offen offset:0 sc1
  buffer_load_dwordx4 a[8:11], v3, s[24:27], s36 offen offset:1024 sc1
  s_add_u32 s36, s36, 4096
  buffer_load_dwordx4 a[12:15], v3, s[24:27], s37 offen offset:1024 sc1
  s_add_u32 s37, s37, 4096
  buffer_load_dwordx4 a[16:19], v3, s[24:27], s36 offen offset:0 sc1
  buffer_load_dwordx4 a[20:23], v3, s[24:27], s37 offen offset:0 sc1
  buffer_load_dwordx4 a[24:27], v3, s[24:27], s36 offen offset:1024 sc1
  s_add_u32 s36, s36, 4096
  buffer_load_dwordx4 a[28:31], v3, s[24:27], s37 offen offset:1024 sc1
  s_add_u32 s37, s37, 4096
  s_waitcnt vmcnt(9)
  buffer_store_dword v44, v45, s[24:27], s15 offen
  ds_read_b128 v[96:99], v42 offset:12288
  ds_read_b128 v[100:103], v42 offset:13312
  ds_read_b128 v[104:107], v42 offset:14336
  ds_read_b128 v[108:111], v42 offset:15360
  ds_read_b128 v[112:115], v42 offset:16384
  ds_read_b128 v[116:119], v42 offset:17408
  ds_read_b128 v[120:123], v42 offset:18432
  buffer_load_dword v11, v10, s[24:27], s14 offen sc1
  ds_read_b128 v[124:127], v42 offset:19456
  ds_read_b128 v[128:131], v42 offset:20480
  ds_read_b128 v[132:135], v42 offset:21504
  ds_read_b128 v[136:139], v40 offset:40960
  ds_read_b128 v[140:143], v40 offset:41984
  ds_read_b128 v[144:147], v40 offset:43008
  ds_read_b128 v[148:151], v40 offset:44032
  buffer_load_dwordx4 a[32:35], v3, s[24:27], s36 offen offset:0 sc1
  ds_read_b128 v[152:155], v40 offset:45056
  ds_read_b128 v[156:159], v40 offset:46080
  buffer_load_dwordx4 a[36:39], v3, s[24:27], s37 offen offset:0 sc1
  s_waitcnt vmcnt(11) lgkmcnt(12)
  v_mfma_f32_16x16x32_bf16 v[20:23], v[96:99], a[0:3], v[20:23]
  s_waitcnt vmcnt(10)
  v_mfma_f32_16x16x32_bf16 v[48:51], v[96:99], a[4:7], 0
  ds_read_b128 v[96:99], v40 offset:47104
  v_mfma_f32_16x16x32_bf16 v[24:27], v[100:103], a[0:3], v[24:27]
  v_mfma_f32_16x16x32_bf16 v[52:55], v[100:103], a[4:7], 0
  buffer_load_dwordx4 a[40:43], v3, s[24:27], s36 offen offset:1024 sc1
  s_add_u32 s36, s36, 4096
  v_mfma_f32_16x16x32_bf16 v[28:31], v[104:107], a[0:3], v[28:31]
  ds_read_b128 v[100:103], v40 offset:48128
  v_mfma_f32_16x16x32_bf16 v[56:59], v[104:107], a[4:7], 0
  ds_read_b128 v[104:107], v40 offset:49152
  v_mfma_f32_16x16x32_bf16 v[32:35], v[108:111], a[0:3], v[32:35]
  v_mfma_f32_16x16x32_bf16 v[60:63], v[108:111], a[4:7], 0
  buffer_load_dwordx4 a[44:47], v3, s[24:27], s37 offen offset:1024 sc1
  s_add_u32 s37, s37, 4096
  s_add_u32 m0, s19, 102400
  s_add_u32 s20, s18, 122880
  s_waitcnt lgkmcnt(11)
  v_mfma_f32_16x16x32_bf16 v[36:39], v[112:115], a[0:3], v[36:39]
  ds_read_b128 v[108:111], v40 offset:50176
  v_mfma_f32_16x16x32_bf16 v[64:67], v[112:115], a[4:7], 0
  s_waitcnt vmcnt(11)
  v_mfma_f32_16x16x32_bf16 v[20:23], v[116:119], a[8:11], v[20:23]
  buffer_load_dwordx4 v3, s[24:27], s20 offen offset:0 sc1 lds
  s_waitcnt vmcnt(11)
  v_mfma_f32_16x16x32_bf16 v[48:51], v[116:119], a[12:15], v[48:51]
  v_mfma_f32_16x16x32_bf16 v[24:27], v[120:123], a[8:11], v[24:27]
  v_mfma_f32_16x16x32_bf16 v[52:55], v[120:123], a[12:15], v[52:55]
  v_mfma_f32_16x16x32_bf16 v[28:31], v[124:127], a[8:11], v[28:31]
  buffer_load_dwordx4 v3, s[24:27], s20 offen offset:1024 sc1 lds
  v_mfma_f32_16x16x32_bf16 v[56:59], v[124:127], a[12:15], v[56:59]
  s_waitcnt lgkmcnt(8)
  v_mfma_f32_16x16x32_bf16 v[32:35], v[128:131], a[8:11], v[32:35]
  v_mfma_f32_16x16x32_bf16 v[60:63], v[128:131], a[12:15], v[60:63]
  v_mfma_f32_16x16x32_bf16 v[36:39], v[132:135], a[8:11], v[36:39]
  buffer_load_dwordx4 v3, s[24:27], s20 offen offset:2048 sc1 lds
  v_mfma_f32_16x16x32_bf16 v[64:67], v[132:135], a[12:15], v[64:67]
  s_waitcnt vmcnt(12)
  v_mfma_f32_16x16x32_bf16 v[20:23], v[136:139], a[16:19], v[20:23]
  s_waitcnt vmcnt(11)
  v_mfma_f32_16x16x32_bf16 v[48:51], v[136:139], a[20:23], v[48:51]
  v_mfma_f32_16x16x32_bf16 v[24:27], v[140:143], a[16:19], v[24:27]
  buffer_load_dwordx4 v3, s[24:27], s20 offen offset:3072 sc1 lds
  s_add_u32 m0, s19, 106496
  s_add_u32 s20, s18, 126976
  v_mfma_f32_16x16x32_bf16 v[52:55], v[140:143], a[20:23], v[52:55]
  buffer_load_dwordx4 v3, s[24:27], s20 offen sc1 lds
  s_add_u32 m0, s19, 122880
  s_add_u32 s20, s18, 143360
  buffer_load_dwordx4 v3, s[24:27], s20 offen offset:0 sc1 lds
  buffer_load_dwordx4 v3, s[24:27], s20 offen offset:1024 sc1 lds
  buffer_load_dwordx4 v3, s[24:27], s20 offen offset:2048 sc1 lds
  buffer_load_dwordx4 v3, s[24:27], s20 offen offset:3072 sc1 lds
  s_add_u32 m0, s19, 126976
  s_add_u32 s20, s18, 147456
  buffer_load_dwordx4 v3, s[24:27], s20 offen sc1 lds
  buffer_load_dwordx4 a[48:51], v3, s[24:27], s36 offen offset:0 sc1
  buffer_load_dwordx4 a[52:55], v3, s[24:27], s37 offen offset:0 sc1
  buffer_load_dwordx4 a[56:59], v3, s[24:27], s36 offen offset:1024 sc1
  s_add_u32 s36, s36, 4096
  buffer_load_dwordx4 a[60:63], v3, s[24:27], s37 offen offset:1024 sc1
  s_add_u32 s37, s37, 4096
  s_waitcnt vmcnt(18)
  v_or_b32 v11, s56, v11
  v_cmp_gt_u32 vcc, 2, v11
  s_nop 4
  s_cbranch_vccz KM_F2_OUT
  s_movk_i32 s22, 0x7fff
KM_F2:
  buffer_load_dword v11, v10, s[24:27], s14 offen sc1
  s_waitcnt vmcnt(0)
  v_cmp_gt_u32 vcc, 2, v11
  s_sub_u32 s22, s22, 1
  s_cbranch_scc1 KM_F2_OUT
  s_cbranch_vccnz KM_F2
KM_F2_OUT:
  s_nop 4
  buffer_load_dwordx4 a[64:67], v3, s[24:27], s36 offen offset:0 sc1
  ds_read_b128 v[112:115], v40 offset:61440
  ds_read_b128 v[116:119], v40 offset:62464
  ds_read_b128 v[120:123], v40 offset:63488
  ds_read_b128 v[124:127], v40 offset:64512
  ds_read_b128 v[128:131], v41 offset:0
  s_waitcnt lgkmcnt(9)
  v_mfma_f32_16x16x32_bf16 v[28:31], v[144:147], a[16:19], v[28:31]
  ds_read_b128 v[132:135], v41 offset:1024
  ds_read_b128 v[136:139], v41 offset:2048
  v_mfma_f32_16x16x32_bf16 v[56:59], v[144:147], a[20:23], v[56:59]
  ds_read_b128 v[140:143], v41 offset:3072
  ds_read_b128 v[144:147], v41 offset:4096
  v_mfma_f32_16x16x32_bf16 v[32:35], v[148:151], a[16:19], v[32:35]
  buffer_load_dwordx4 a[68:71], v3, s[24:27], s37 offen offset:0 sc1
  v_mfma_f32_16x16x32_bf16 v[60:63], v[148:151], a[20:23], v[60:63]
  ds_read_b128 v[148:151], v41 offset:5120
  v_mfma_f32_16x16x32_bf16 v[36:39], v[152:155], a[16:19], v[36:39]
  v_mfma_f32_16x16x32_bf16 v[64:67], v[152:155], a[20:23], v[64:67]
  ds_read_b128 v[152:155], v40 offset:0
  v_mfma_f32_16x16x32_bf16 v[20:23], v[156:159], a[24:27], v[20:23]
  buffer_load_dwordx4 a[72:75], v3, s[24:27], s36 offen offset:1024 sc1
  s_add_u32 s36, s36, 4096
  v_mfma_f32_16x16x32_bf16 v[48:51], v[156:159], a[28:31], v[48:51]
  ds_read_b128 v[156:159], v40 offset:1024
  s_waitcnt lgkmcnt(12)
  v_mfma_f32_16x16x32_bf16 v[24:27], v[96:99], a[24:27], v[24:27]
  v_mfma_f32_16x16x32_bf16 v[52:55], v[96:99], a[28:31], v[52:55]
  ds_read_b128 v[96:99], v40 offset:2048
  v_mfma_f32_16x16x32_bf16 v[28:31], v[100:103], a[24:27], v[28:31]
  buffer_load_dwordx4 a[76:79], v3, s[24:27], s37 offen offset:1024 sc1
  s_add_u32 s37, s37, 4096
  v_mfma_f32_16x16x32_bf16 v[56:59], v[100:103], a[28:31], v[56:59]
  ds_read_b128 v[100:103], v40 offset:3072
  v_mfma_f32_16x16x32_bf16 v[32:35], v[104:107], a[24:27], v[32:35]
  v_mfma_f32_16x16x32_bf16 v[60:63], v[104:107], a[28:31], v[60:63]
  ds_read_b128 v[104:107], v40 offset:4096
  v_mfma_f32_16x16x32_bf16 v[36:39], v[108:111], a[24:27], v[36:39]
  buffer_load_dword v11, v10, s[24:27], s14 offen sc1
  v_mfma_f32_16x16x32_bf16 v[64:67], v[108:111], a[28:31], v[64:67]
  ds_read_b128 v[108:111], v40 offset:5120
  s_waitcnt vmcnt(22) lgkmcnt(12)
  v_mfma_f32_16x16x32_bf16 v[20:23], v[112:115], a[32:35], v[20:23]
  buffer_load_dwordx4 a[80:83], v3, s[24:27], s36 offen offset:0 sc1
  s_waitcnt vmcnt(22)
  v_mfma_f32_16x16x32_bf16 v[48:51], v[112:115], a[36:39], v[48:51]
  ds_read_b128 v[112:115], v40 offset:6144
  v_mfma_f32_16x16x32_bf16 v[24:27], v[116:119], a[32:35], v[24:27]
  v_mfma_f32_16x16x32_bf16 v[52:55], v[116:119], a[36:39], v[52:55]
  ds_read_b128 v[116:119], v40 offset:7168
  v_mfma_f32_16x16x32_bf16 v[28:31], v[120:123], a[32:35], v[28:31]
  buffer_load_dwordx4 a[84:87], v3, s[24:27], s37 offen offset:0 sc1
  v_mfma_f32_16x16x32_bf16 v[56:59], v[120:123], a[36:39], v[56:59]
  ds_read_b128 v[120:123], v40 offset:8192
  v_mfma_f32_16x16x32_bf16 v[32:35], v[124:127], a[32:35], v[32:35]
  v_mfma_f32_16x16x32_bf16 v[60:63], v[124:127], a[36:39], v[60:63]
  ds_read_b128 v[124:127], v40 offset:9216
  s_waitcnt lgkmcnt(12)
  v_mfma_f32_16x16x32_bf16 v[36:39], v[128:131], a[32:35], v[36:39]
  buffer_load_dwordx4 a[88:91], v3, s[24:27], s36 offen offset:1024 sc1
  s_add_u32 s36, s36, 4096
  v_mfma_f32_16x16x32_bf16 v[64:67], v[128:131], a[36:39], v[64:67]
  ds_read_b128 v[128:131], v40 offset:20480
  s_waitcnt vmcnt(23)
  v_mfma_f32_16x16x32_bf16 v[20:23], v[132:135], a[40:43], v[20:23]
  s_waitcnt vmcnt(22)
  v_mfma_f32_16x16x32_bf16 v[48:51], v[132:135], a[44:47], v[48:51]
  ds_read_b128 v[132:135], v40 offset:21504
  v_mfma_f32_16x16x32_bf16 v[24:27], v[136:139], a[40:43], v[24:27]
  buffer_load_dwordx4 a[92:95], v3, s[24:27], s37 offen offset:1024 sc1
  s_add_u32 s37, s37, 4096
  v_mfma_f32_16x16x32_bf16 v[52:55], v[136:139], a[44:47], v[52:55]
  ds_read_b128 v[136:139], v40 offset:22528
  v_mfma_f32_16x16x32_bf16 v[28:31], v[140:143], a[40:43], v[28:31]
  v_mfma_f32_16x16x32_bf16 v[56:59], v[140:143], a[44:47], v[56:59]
  ds_read_b128 v[140:143], v40 offset:23552
  s_waitcnt lgkmcnt(12)
  v_mfma_f32_16x16x32_bf16 v[32:35], v[144:147], a[40:43], v[32:35]
  buffer_load_dwordx4 a[96:99], v3, s[24:27], s36 offen offset:0 sc1
  v_mfma_f32_16x16x32_bf16 v[60:63], v[144:147], a[44:47], v[60:63]
  ds_read_b128 v[144:147], v40 offset:24576
  v_mfma_f32_16x16x32_bf16 v[36:39], v[148:151], a[40:43], v[36:39]
  v_mfma_f32_16x16x32_bf16 v[64:67], v[148:151], a[44:47], v[64:67]
  ds_read_b128 v[148:151], v40 offset:25600
  s_waitcnt vmcnt(13)
  v_mfma_f32_16x16x32_bf16 v[20:23], v[152:155], a[48:51], v[20:23]
  buffer_load_dwordx4 a[100:103], v3, s[24:27], s37 offen offset:0 sc1
  s_waitcnt vmcnt(13)
  v_mfma_f32_16x16x32_bf16 v[48:51], v[152:155], a[52:55], v[48:51]
  ds_read_b128 v[152:155], v40 offset:26624
  v_mfma_f32_16x16x32_bf16 v[24:27], v[156:159], a[48:51], v[24:27]
  v_mfma_f32_16x16x32_bf16 v[52:55], v[156:159], a[52:55], v[52:55]
  ds_read_b128 v[156:159], v40 offset:27648
  s_waitcnt lgkmcnt(12)
  v_mfma_f32_16x16x32_bf16 v[28:31], v[96:99], a[48:51], v[28:31]
  buffer_load_dwordx4 a[104:107], v3, s[24:27], s36 offen offset:1024 sc1
  s_add_u32 s36, s36, 4096
  v_mfma_f32_16x16x32_bf16 v[56:59], v[96:99], a[52:55], v[56:59]
  v_mfma_f32_16x16x32_bf16 v[32:35], v[100:103], a[48:51], v[32:35]
  v_mfma_f32_16x16x32_bf16 v[60:63], v[100:103], a[52:55], v[60:63]
  v_mfma_f32_16x16x32_bf16 v[36:39], v[104:107], a[48:51], v[36:39]
  buffer_load_dwordx4 a[108:111], v3, s[24:27], s37 offen offset:1024 sc1
  s_add_u32 s37, s37, 4096
  v_mfma_f32_16x16x32_bf16 v[64:67], v[104:107], a[52:55], v[64:67]
  s_waitcnt vmcnt(14)
  v_mfma_f32_16x16x32_bf16 v[20:23], v[108:111], a[56:59], v[20:23]
  s_waitcnt vmcnt(13)
  v_mfma_f32_16x16x32_bf16 v[48:51], v[108:111], a[60:63], v[48:51]
  s_waitcnt lgkmcnt(8)
  v_mfma_f32_16x16x32_bf16 v[24:27], v[112:115], a[56:59], v[24:27]
  buffer_load_dwordx4 a[112:115], v3, s[24:27], s36 offen offset:0 sc1
  v_mfma_f32_16x16x32_bf16 v[52:55], v[112:115], a[60:63], v[52:55]
  v_mfma_f32_16x16x32_bf16 v[28:31], v[116:119], a[56:59], v[28:31]
  v_mfma_f32_16x16x32_bf16 v[56:59], v[116:119], a[60:63], v[56:59]
  v_mfma_f32_16x16x32_bf16 v[32:35], v[120:123], a[56:59], v[32:35]
  buffer_load_dwordx4 a[116:119], v3, s[24:27], s37 offen offset:0 sc1
  v_mfma_f32_16x16x32_bf16 v[60:63], v[120:123], a[60:63], v[60:63]
  v_mfma_f32_16x16x32_bf16 v[36:39], v[124:127], a[56:59], v[36:39]
  v_mfma_f32_16x16x32_bf16 v[64:67], v[124:127], a[60:63], v[64:67]
  buffer_load_dwordx4 a[120:123], v3, s[24:27], s36 offen offset:1024 sc1
  s_add_u32 s36, s36, 4096
  buffer_load_dwordx4 a[124:127], v3, s[24:27], s37 offen offset:1024 sc1
  s_add_u32 s37, s37, 4096
  s_waitcnt vmcnt(12)
  v_or_b32 v11, s56, v11
  v_cmp_gt_u32 vcc, 3, v11
  s_nop 4
  s_cbranch_vccz KM_F3_OUT
  s_movk_i32 s22, 0x7fff
KM_F3:
  buffer_load_dword v11, v10, s[24:27], s14 offen sc1
  s_waitcnt vmcnt(0)
  v_cmp_gt_u32 vcc, 3, v11
  s_sub_u32 s22, s22, 1
  s_cbranch_scc1 KM_F3_OUT
  s_cbranch_vccnz KM_F3
KM_F3_OUT:
  s_nop 4
  s_barrier
  buffer_load_dwordx4 a[128:131], v3, s[24:27], s36 offen offset:0 sc1
  ds_read_b128 v[96:99], v40 offset:28672
  ds_read_b128 v[100:103], v40 offset:29696
  ds_read_b128 v[104:107], v41 offset:16384
  ds_read_b128 v[108:111], v41 offset:17408
  ds_read_b128 v[112:115], v41 offset:18432
  ds_read_b128 v[116:119], v41 offset:19456
  ds_read_b128 v[120:123], v41 offset:20480
  ds_read_b128 v[124:127], v41 offset:21504
  s_waitcnt lgkmcnt(12)
  v_mfma_f32_16x16x32_bf16 v[20:23], v[128:131], a[64:67], v[20:23]
  ds_write_b128 v19, a[160:163] offset:12288
  s_mov_b32 s12, s6
  v_mfma_f32_16x16x32_bf16 v[48:51], v[128:131], a[68:71], v[48:51]
  ds_read_b128 v[128:131], v41 offset:22528
  buffer_load_dwordx4 a[132:135], v3, s[24:27], s37 offen offset:0 sc1
  v_mfma_f32_16x16x32_bf16 v[24:27], v[132:135], a[64:67], v[24:27]
  s_mov_b32 s13, s7
  s_mov_b32 s14, 2621440
  v_mfma_f32_16x16x32_bf16 v[52:55], v[132:135], a[68:71], v[52:55]
  ds_read_b128 v[132:135], v41 offset:23552
  ds_write_b128 v17, a[180:183] offset:40960
  v_mfma_f32_16x16x32_bf16 v[28:31], v[136:139], a[64:67], v[28:31]
  s_mov_b32 s15, 0x20000
  v_mfma_f32_16x16x32_bf16 v[56:59], v[136:139], a[68:71], v[56:59]
  ds_read_b128 v[136:139], v41 offset:24576
  buffer_load_dwordx4 a[136:139], v3, s[24:27], s36 offen offset:1024 sc1
  s_add_u32 s36, s36, 4096
  v_mfma_f32_16x16x32_bf16 v[32:35], v[140:143], a[64:67], v[32:35]
  ds_write_b128 v17, a[200:203] offset:61440
  v_mfma_f32_16x16x32_bf16 v[60:63], v[140:143], a[68:71], v[60:63]
  ds_read_b128 v[140:143], v41 offset:25600
  s_waitcnt lgkmcnt(15)
  v_mfma_f32_16x16x32_bf16 v[36:39], v[144:147], a[64:67], v[36:39]
  v_mfma_f32_16x16x32_bf16 v[64:67], v[144:147], a[68:71], v[64:67]
  buffer_load_dwordx4 a[140:143], v3, s[24:27], s37 offen offset:1024 sc1
  s_add_u32 s37, s37, 4096
  v_mfma_f32_16x16x32_bf16 v[20:23], v[148:151], a[72:75], v[20:23]
  ds_read_b128 v[144:147], v41 offset:36864
  ds_write_b128 v17, a[220:223] offset:0
  v_mfma_f32_16x16x32_bf16 v[48:51], v[148:151], a[76:79], v[48:51]
  ds_read_b128 v[148:151], v41 offset:37888
  v_mfma_f32_16x16x32_bf16 v[24:27], v[152:155], a[72:75], v[24:27]
  v_mfma_f32_16x16x32_bf16 v[52:55], v[152:155], a[76:79], v[52:55]
  buffer_load_dwordx4 a[144:147], v3, s[24:27], s36 offen offset:0 sc1
  ds_read_b128 v[152:155], v41 offset:38912
  v_mfma_f32_16x16x32_bf16 v[28:31], v[156:159], a[72:75], v[28:31]
  ds_write_b128 v19, a[164:167] offset:13312
  v_mfma_f32_16x16x32_bf16 v[56:59], v[156:159], a[76:79], v[56:59]
  ds_read_b128 v[156:159], v41 offset:39936
  s_waitcnt lgkmcnt(15)
  v_mfma_f32_16x16x32_bf16 v[32:35], v[96:99], a[72:75], v[32:35]
  v_mfma_f32_16x16x32_bf16 v[60:63], v[96:99], a[76:79], v[60:63]
  buffer_load_dwordx4 a[148:151], v3, s[24:27], s37 offen offset:0 sc1
  ds_read_b128 v[96:99], v41 offset:40960
  v_mfma_f32_16x16x32_bf16 v[36:39], v[100:103], a[72:75], v[36:39]
  ds_write_b128 v17, a[184:187] offset:41984
  v_mfma_f32_16x16x32_bf16 v[64:67], v[100:103], a[76:79], v[64:67]
  ds_read_b128 v[100:103], v41 offset:41984
  s_waitcnt vmcnt(17)
  v_mfma_f32_16x16x32_bf16 v[20:23], v[104:107], a[80:83], v[20:23]
  s_waitcnt vmcnt(16)
  v_mfma_f32_16x16x32_bf16 v[48:51], v[104:107], a[84:87], v[48:51]
  buffer_load_dwordx4 a[152:155], v3, s[24:27], s36 offen offset:1024 sc1
  s_add_u32 s36, s36, 4096
  ds_read_b128 v[104:107], v41 offset:43008
  v_mfma_f32_16x16x32_bf16 v[24:27], v[108:111], a[80:83], v[24:27]
  ds_write_b128 v17, a[204:207] offset:62464
  v_mfma_f32_16x16x32_bf16 v[52:55], v[108:111], a[84:87], v[52:55]
  ds_read_b128 v[108:111], v41 offset:44032
  v_mfma_f32_16x16x32_bf16 v[28:31], v[112:115], a[80:83], v[28:31]
  v_mfma_f32_16x16x32_bf16 v[56:59], v[112:115], a[84:87], v[56:59]
  buffer_load_dwordx4 a[156:159], v3, s[24:27], s37 offen offset:1024 sc1
  s_add_u32 s37, s37, 4096
  v_mfma_f32_16x16x32_bf16 v[32:35], v[116:119], a[80:83], v[32:35]
  ds_read_b128 v[112:115], v41 offset:45056
  ds_write_b128 v17, a[224:227] offset:1024
  v_mfma_f32_16x16x32_bf16 v[60:63], v[116:119], a[84:87], v[60:63]
  ds_read_b128 v[116:119], v41 offset:46080
  s_waitcnt lgkmcnt(15)
  v_mfma_f32_16x16x32_bf16 v[36:39], v[120:123], a[80:83], v[36:39]
  v_mfma_f32_16x16x32_bf16 v[64:67], v[120:123], a[84:87], v[64:67]
  buffer_load_dwordx4 a[240:243], v3, s[24:27], s36 offen offset:0 sc1
  ds_read_b128 v[120:123], v41 offset:57344
  s_waitcnt vmcnt(18)
  v_mfma_f32_16x16x32_bf16 v[20:23], v[124:127], a[88:91], v[20:23]
  ds_write_b128 v19, a[168:171] offset:14336
  s_waitcnt vmcnt(17)
  v_mfma_f32_16x16x32_bf16 v[48:51], v[124:127], a[92:95], v[48:51]
  ds_read_b128 v[124:127], v41 offset:58368
  v_mfma_f32_16x16x32_bf16 v[24:27], v[128:131], a[88:91], v[24:27]
  v_mfma_f32_16x16x32_bf16 v[52:55], v[128:131], a[92:95], v[52:55]
  buffer_load_dwordx4 a[244:247], v3, s[24:27], s37 offen offset:0 sc1
  ds_write_b128 v17, a[188:191] offset:43008
  v_mfma_f32_16x16x32_bf16 v[28:31], v[132:135], a[88:91], v[28:31]
  ds_read_b128 v[128:131], v41 offset:59392
  v_mfma_f32_16x16x32_bf16 v[56:59], v[132:135], a[92:95], v[56:59]
  ds_read_b128 v[132:135], v41 offset:60416
  v_mfma_f32_16x16x32_bf16 v[32:35], v[136:139], a[88:91], v[32:35]
  v_mfma_f32_16x16x32_bf16 v[60:63], v[136:139], a[92:95], v[60:63]
  buffer_load_dwordx4 a[248:251], v3, s[24:27], s36 offen offset:1024 sc1
  s_add_u32 s36, s36, 4096
  v_mfma_f32_16x16x32_bf16 v[36:39], v[140:143], a[88:91], v[36:39]
  ds_write_b128 v17, a[208:211] offset:63488
  ds_read_b128 v[136:139], v41 offset:61440
  v_mfma_f32_16x16x32_bf16 v[64:67], v[140:143], a[92:95], v[64:67]
  ds_read_b128 v[140:143], v41 offset:62464
  s_waitcnt vmcnt(18) lgkmcnt(15)
  v_mfma_f32_16x16x32_bf16 v[20:23], v[144:147], a[96:99], v[20:23]
  s_waitcnt vmcnt(17)
  v_mfma_f32_16x16x32_bf16 v[48:51], v[144:147], a[100:103], v[48:51]
  buffer_load_dwordx4 a[252:255], v3, s[24:27], s37 offen offset:1024 sc1
  s_add_u32 s37, s37, 4096
  v_mfma_f32_16x16x32_bf16 v[24:27], v[148:151], a[96:99], v[24:27]
  ds_write_b128 v17, a[228:231] offset:2048
  ds_read_b128 v[144:147], v41 offset:63488
  v_mfma_f32_16x16x32_bf16 v[52:55], v[148:151], a[100:103], v[52:55]
  ds_read_b128 v[148:151], v41 offset:64512
  v_mfma_f32_16x16x32_bf16 v[28:31], v[152:155], a[96:99], v[28:31]
  v_mfma_f32_16x16x32_bf16 v[56:59], v[152:155], a[100:103], v[56:59]
  buffer_load_dwordx4 a[0:3], v3, s[24:27], s36 offen offset:0 sc1
  ds_write_b128 v19, a[172:175] offset:15360
  v_mfma_f32_16x16x32_bf16 v[32:35], v[156:159], a[96:99], v[32:35]
  ds_read_b128 v[152:155], v42 offset:0
  v_mfma_f32_16x16x32_bf16 v[60:63], v[156:159], a[100:103], v[60:63]
  ds_read_b128 v[156:159], v42 offset:1024
  v_mfma_f32_16x16x32_bf16 v[36:39], v[96:99], a[96:99], v[36:39]
  v_mfma_f32_16x16x32_bf16 v[64:67], v[96:99], a[100:103], v[64:67]
  buffer_load_dwordx4 a[4:7], v3, s[24:27], s37 offen offset:0 sc1
  ds_write_b128 v17, a[192:195] offset:44032
  s_waitcnt vmcnt(19)
  v_mfma_f32_16x16x32_bf16 v[20:23], v[100:103], a[104:107], v[20:23]
  s_waitcnt vmcnt(18)
  v_mfma_f32_16x16x32_bf16 v[48:51], v[100:103], a[108:111], v[48:51]
  s_waitcnt lgkmcnt(15)
  v_mfma_f32_16x16x32_bf16 v[24:27], v[104:107], a[104:107], v[24:27]
  v_mfma_f32_16x16x32_bf16 v[52:55], v[104:107], a[108:111], v[52:55]
  ds_write_b128 v17, a[212:215] offset:64512
  v_mfma_f32_16x16x32_bf16 v[28:31], v[108:111], a[104:107], v[28:31]
  v_mfma_f32_16x16x32_bf16 v[56:59], v[108:111], a[108:111], v[56:59]
  v_mfma_f32_16x16x32_bf16 v[32:35], v[112:115], a[104:107], v[32:35]
  ds_write_b128 v17, a[232:235] offset:3072
  v_mfma_f32_16x16x32_bf16 v[60:63], v[112:115], a[108:111], v[60:63]
  v_mfma_f32_16x16x32_bf16 v[36:39], v[116:119], a[104:107], v[36:39]
  v_mfma_f32_16x16x32_bf16 v[64:67], v[116:119], a[108:111], v[64:67]
  s_waitcnt vmcnt(17)
  v_mfma_f32_16x16x32_bf16 v[20:23], v[120:123], a[112:115], v[20:23]
  ds_write_b128 v19, a[176:179] offset:16384
  s_waitcnt vmcnt(16)
  v_mfma_f32_16x16x32_bf16 v[48:51], v[120:123], a[116:119], v[48:51]
  s_waitcnt lgkmcnt(13)
  v_mfma_f32_16x16x32_bf16 v[24:27], v[124:127], a[112:115], v[24:27]
  v_mfma_f32_16x16x32_bf16 v[52:55], v[124:127], a[116:119], v[52:55]
  ds_write_b128 v17, a[196:199] offset:45056
  ds_write_b128 v18, a[216:219] offset:0
  ds_write_b128 v17, a[236:239] offset:4096
  s_waitcnt lgkmcnt(0)
  s_barrier
  buffer_load_dwordx4 a[8:11], v3, s[24:27], s36 offen offset:1024 sc1
  ds_read_b128 v[96:99], v42 offset:12288
  ds_read_b128 v[100:103], v42 offset:13312
  ds_read_b128 v[104:107], v42 offset:14336
  ds_read_b128 v[108:111], v42 offset:15360
  ds_read_b128 v[112:115], v42 offset:16384
  ds_read_b128 v[116:119], v42 offset:17408
  ds_read_b128 v[120:123], v42 offset:18432
  ds_read_b128 v[124:127], v42 offset:19456
  v_mfma_f32_16x16x32_bf16 v[28:31], v[128:131], a[112:115], v[28:31]
  s_add_u32 s36, s36, 4096
  s_mul_i32 s40, s28, 20480
  v_mfma_f32_16x16x32_bf16 v[56:59], v[128:131], a[116:119], v[56:59]
  ds_read_b128 v[128:131], v42 offset:20480
  buffer_load_dwordx4 a[12:15], v3, s[24:27], s37 offen offset:1024 sc1
  v_mfma_f32_16x16x32_bf16 v[32:35], v[132:135], a[112:115], v[32:35]
  s_add_u32 s37, s37, 4096
  s_mul_i32 s32, s30, 320
  v_mfma_f32_16x16x32_bf16 v[60:63], v[132:135], a[116:119], v[60:63]
  ds_read_b128 v[132:135], v42 offset:21504
  s_add_u32 s40, s40, s32
  v_mfma_f32_16x16x32_bf16 v[36:39], v[136:139], a[112:115], v[36:39]
  s_mul_i32 s32, s31, 192
  s_add_u32 s41, s40, s32
  v_mfma_f32_16x16x32_bf16 v[64:67], v[136:139], a[116:119], v[64:67]
  ds_read_b128 v[136:139], v40 offset:40960
  v_mul_u32_u24 v4, 1280, v1
  s_waitcnt vmcnt(17)
  v_mfma_f32_16x16x32_bf16 v[20:23], v[140:143], a[120:123], v[20:23]
  s_lshl_b32 s32, s31, 5
  v_lshl_add_u32 v5, v2, 4, v4
  s_waitcnt vmcnt(16)
  v_mfma_f32_16x16x32_bf16 v[48:51], v[140:143], a[124:127], v[48:51]
  ds_read_b128 v[140:143], v40 offset:41984
  v_lshl_add_u32 v6, v2, 3, v4
  v_mfma_f32_16x16x32_bf16 v[24:27], v[144:147], a[120:123], v[24:27]
  s_add_u32 s42, s40, s32
  v_mfma_f32_16x16x32_bf16 v[52:55], v[144:147], a[124:127], v[52:55]
  ds_read_b128 v[144:147], v40 offset:43008
  v_mfma_f32_16x16x32_bf16 v[28:31], v[148:151], a[120:123], v[28:31]
  v_mfma_f32_16x16x32_bf16 v[56:59], v[148:151], a[124:127], v[56:59]
  ds_read_b128 v[148:151], v40 offset:44032
  v_mfma_f32_16x16x32_bf16 v[32:35], v[152:155], a[120:123], v[32:35]
  v_mfma_f32_16x16x32_bf16 v[60:63], v[152:155], a[124:127], v[60:63]
  ds_read_b128 v[152:155], v40 offset:45056
  v_mfma_f32_16x16x32_bf16 v[36:39], v[156:159], a[120:123], v[36:39]
  v_mfma_f32_16x16x32_bf16 v[64:67], v[156:159], a[124:127], v[64:67]
  ds_read_b128 v[156:159], v40 offset:46080
  s_waitcnt vmcnt(15) lgkmcnt(12)
  v_mfma_f32_16x16x32_bf16 v[20:23], v[96:99], a[128:131], v[20:23]
  s_waitcnt vmcnt(14)
  v_mfma_f32_16x16x32_bf16 v[48:51], v[96:99], a[132:135], v[48:51]
  ds_read_b128 v[96:99], v40 offset:47104
  v_mfma_f32_16x16x32_bf16 v[24:27], v[100:103], a[128:131], v[24:27]
  v_mfma_f32_16x16x32_bf16 v[52:55], v[100:103], a[132:135], v[52:55]
  ds_read_b128 v[100:103], v40 offset:48128
  v_mfma_f32_16x16x32_bf16 v[28:31], v[104:107], a[128:131], v[28:31]
  v_mfma_f32_16x16x32_bf16 v[56:59], v[104:107], a[132:135], v[56:59]
  ds_read_b128 v[104:107], v40 offset:49152
  v_mfma_f32_16x16x32_bf16 v[32:35], v[108:111], a[128:131], v[32:35]
  v_mfma_f32_16x16x32_bf16 v[60:63], v[108:111], a[132:135], v[60:63]
  ds_read_b128 v[108:111], v40 offset:50176
  s_waitcnt lgkmcnt(12)
  v_mfma_f32_16x16x32_bf16 v[36:39], v[112:115], a[128:131], v[36:39]
  v_mfma_f32_16x16x32_bf16 v[64:67], v[112:115], a[132:135], v[64:67]
  ds_read_b128 v[112:115], v40 offset:61440
  s_waitcnt vmcnt(13)
  v_mfma_f32_16x16x32_bf16 v[20:23], v[116:119], a[136:139], v[20:23]
  s_waitcnt vmcnt(12)
  v_mfma_f32_16x16x32_bf16 v[48:51], v[116:119], a[140:143], v[48:51]
  ds_read_b128 v[116:119], v40 offset:62464
  v_mfma_f32_16x16x32_bf16 v[24:27], v[120:123], a[136:139], v[24:27]
  v_mfma_f32_16x16x32_bf16 v[52:55], v[120:123], a[140:143], v[52:55]
  ds_read_b128 v[120:123], v40 offset:63488
  v_mfma_f32_16x16x32_bf16 v[28:31], v[124:127], a[136:139], v[28:31]
  v_mfma_f32_16x16x32_bf16 v[56:59], v[124:127], a[140:143], v[56:59]
  ds_read_b128 v[124:127], v40 offset:64512
  s_waitcnt lgkmcnt(12)
  v_mfma_f32_16x16x32_bf16 v[32:35], v[128:131], a[136:139], v[32:35]
  v_mfma_f32_16x16x32_bf16 v[60:63], v[128:131], a[140:143], v[60:63]
  ds_read_b128 v[128:131], v41 offset:0
  v_mfma_f32_16x16x32_bf16 v[36:39], v[132:135], a[136:139], v[36:39]
  v_mfma_f32_16x16x32_bf16 v[64:67], v[132:135], a[140:143], v[64:67]
  ds_read_b128 v[132:135], v41 offset:1024
  s_waitcnt vmcnt(11)
  v_mfma_f32_16x16x32_bf16 v[20:23], v[136:139], a[144:147], v[20:23]
  s_waitcnt vmcnt(10)
  v_mfma_f32_16x16x32_bf16 v[48:51], v[136:139], a[148:151], v[48:51]
  ds_read_b128 v[136:139], v41 offset:2048
  v_mfma_f32_16x16x32_bf16 v[24:27], v[140:143], a[144:147], v[24:27]
  v_mfma_f32_16x16x32_bf16 v[52:55], v[140:143], a[148:151], v[52:55]
  ds_read_b128 v[140:143], v41 offset:3072
  s_waitcnt lgkmcnt(12)
  v_mfma_f32_16x16x32_bf16 v[28:31], v[144:147], a[144:147], v[28:31]
  v_mfma_f32_16x16x32_bf16 v[56:59], v[144:147], a[148:151], v[56:59]
  ds_read_b128 v[144:147], v41 offset:4096
  v_mfma_f32_16x16x32_bf16 v[32:35], v[148:151], a[144:147], v[32:35]
  v_mfma_f32_16x16x32_bf16 v[60:63], v[148:151], a[148:151], v[60:63]
  ds_read_b128 v[148:151], v41 offset:5120
  v_mfma_f32_16x16x32_bf16 v[36:39], v[152:155], a[144:147], v[36:39]
  v_mfma_f32_16x16x32_bf16 v[64:67], v[152:155], a[148:151], v[64:67]
  ds_read_b128 v[152:155], v40 offset:0
  s_waitcnt vmcnt(9)
  v_mfma_f32_16x16x32_bf16 v[20:23], v[156:159], a[152:155], v[20:23]
  s_waitcnt vmcnt(8)
  v_mfma_f32_16x16x32_bf16 v[48:51], v[156:159], a[156:159], v[48:51]
  ds_read_b128 v[156:159], v40 offset:1024
  s_waitcnt lgkmcnt(12)
  v_mfma_f32_16x16x32_bf16 v[24:27], v[96:99], a[152:155], v[24:27]
  v_mfma_f32_16x16x32_bf16 v[52:55], v[96:99], a[156:159], v[52:55]
  ds_read_b128 v[96:99], v40 offset:2048
  v_mfma_f32_16x16x32_bf16 v[28:31], v[100:103], a[152:155], v[28:31]
  v_mfma_f32_16x16x32_bf16 v[56:59], v[100:103], a[156:159], v[56:59]
  ds_read_b128 v[100:103], v40 offset:3072
  v_mfma_f32_16x16x32_bf16 v[32:35], v[104:107], a[152:155], v[32:35]
  v_mfma_f32_16x16x32_bf16 v[60:63], v[104:107], a[156:159], v[60:63]
  ds_read_b128 v[104:107], v40 offset:4096
  v_mfma_f32_16x16x32_bf16 v[36:39], v[108:111], a[152:155], v[36:39]
  v_mfma_f32_16x16x32_bf16 v[64:67], v[108:111], a[156:159], v[64:67]
  ds_read_b128 v[108:111], v40 offset:5120
  s_waitcnt vmcnt(7) lgkmcnt(12)
  v_mfma_f32_16x16x32_bf16 v[20:23], v[112:115], a[240:243], v[20:23]
  s_waitcnt vmcnt(6)
  v_mfma_f32_16x16x32_bf16 v[48:51], v[112:115], a[244:247], v[48:51]
  ds_read_b128 v[112:115], v40 offset:6144
  v_mfma_f32_16x16x32_bf16 v[24:27], v[116:119], a[240:243], v[24:27]
  v_mfma_f32_16x16x32_bf16 v[52:55], v[116:119], a[244:247], v[52:55]
  ds_read_b128 v[116:119], v40 offset:7168
  v_mfma_f32_16x16x32_bf16 v[28:31], v[120:123], a[240:243], v[28:31]
  v_mfma_f32_16x16x32_bf16 v[56:59], v[120:123], a[244:247], v[56:59]
  ds_read_b128 v[120:123], v40 offset:8192
  v_mfma_f32_16x16x32_bf16 v[32:35], v[124:127], a[240:243], v[32:35]
  v_mfma_f32_16x16x32_bf16 v[60:63], v[124:127], a[244:247], v[60:63]
  ds_read_b128 v[124:127], v40 offset:9216
  s_waitcnt lgkmcnt(12)
  v_mfma_f32_16x16x32_bf16 v[64:67], v[128:131], a[244:247], v[64:67]
  s_waitcnt vmcnt(4)
  v_mfma_f32_16x16x32_bf16 v[48:51], v[132:135], a[252:255], v[48:51]
  v_mfma_f32_16x16x32_bf16 v[52:55], v[136:139], a[252:255], v[52:55]
  v_mfma_f32_16x16x32_bf16 v[56:59], v[140:143], a[252:255], v[56:59]
  s_waitcnt lgkmcnt(8)
  v_mfma_f32_16x16x32_bf16 v[60:63], v[144:147], a[252:255], v[60:63]
  v_mfma_f32_16x16x32_bf16 v[64:67], v[148:151], a[252:255], v[64:67]
  s_waitcnt vmcnt(2)
  v_mfma_f32_16x16x32_bf16 v[48:51], v[152:155], a[4:7], v[48:51]
  v_mfma_f32_16x16x32_bf16 v[52:55], v[156:159], a[4:7], v[52:55]
  s_waitcnt lgkmcnt(7)
  v_mfma_f32_16x16x32_bf16 v[56:59], v[96:99], a[4:7], v[56:59]
  s_waitcnt lgkmcnt(6)
  v_mfma_f32_16x16x32_bf16 v[60:63], v[100:103], a[4:7], v[60:63]
  s_waitcnt lgkmcnt(5)
  v_mfma_f32_16x16x32_bf16 v[64:67], v[104:107], a[4:7], v[64:67]
  s_waitcnt vmcnt(0) lgkmcnt(4)
  v_mfma_f32_16x16x32_bf16 v[48:51], v[108:111], a[12:15], v[48:51]
  v_mfma_f32_16x16x32_bf16 v[36:39], v[128:131], a[240:243], v[36:39]
  s_waitcnt lgkmcnt(3)
  v_mfma_f32_16x16x32_bf16 v[52:55], v[112:115], a[12:15], v[52:55]
  s_nop 4
  ds_write_b128 v17, v[48:51] offset:20480
  s_waitcnt lgkmcnt(3)
  v_mfma_f32_16x16x32_bf16 v[56:59], v[116:119], a[12:15], v[56:59]
  s_waitcnt lgkmcnt(2)
  v_mfma_f32_16x16x32_bf16 v[60:63], v[120:123], a[12:15], v[60:63]
  s_waitcnt lgkmcnt(1)
  v_mfma_f32_16x16x32_bf16 v[64:67], v[124:127], a[12:15], v[64:67]
  ds_write_b128 v17, v[52:55] offset:21504
  v_mfma_f32_16x16x32_bf16 v[20:23], v[132:135], a[248:251], v[20:23]
  v_mfma_f32_16x16x32_bf16 v[24:27], v[136:139], a[248:251], v[24:27]
  v_mfma_f32_16x16x32_bf16 v[28:31], v[140:143], a[248:251], v[28:31]
  v_mfma_f32_16x16x32_bf16 v[32:35], v[144:147], a[248:251], v[32:35]
  ds_write_b128 v17, v[56:59] offset:22528
  v_mfma_f32_16x16x32_bf16 v[36:39], v[148:151], a[248:251], v[36:39]
  v_mfma_f32_16x16x32_bf16 v[20:23], v[152:155], a[0:3], v[20:23]
  v_mfma_f32_16x16x32_bf16 v[24:27], v[156:159], a[0:3], v[24:27]
  ds_write_b128 v17, v[60:63] offset:23552
  v_mfma_f32_16x16x32_bf16 v[28:31], v[96:99], a[0:3], v[28:31]
  v_mfma_f32_16x16x32_bf16 v[32:35], v[100:103], a[0:3], v[32:35]
  v_mfma_f32_16x16x32_bf16 v[36:39], v[104:107], a[0:3], v[36:39]
  v_mfma_f32_16x16x32_bf16 v[20:23], v[108:111], a[8:11], v[20:23]
  ds_write_b128 v17, v[64:67] offset:24576
  v_mfma_f32_16x16x32_bf16 v[24:27], v[112:115], a[8:11], v[24:27]
  v_mfma_f32_16x16x32_bf16 v[28:31], v[116:119], a[8:11], v[28:31]
  v_mfma_f32_16x16x32_bf16 v[32:35], v[120:123], a[8:11], v[32:35]
  v_mfma_f32_16x16x32_bf16 v[36:39], v[124:127], a[8:11], v[36:39]
  s_waitcnt lgkmcnt(0)
  s_barrier
  ds_read_b128 v[64:67], v43 offset:24576
  ds_read_b128 v[48:51], v43 offset:20480
  ds_read_b128 v[52:55], v43 offset:21504
  ds_read_b128 v[56:59], v43 offset:22528
  ds_read_b128 v[60:63], v43 offset:23552
  s_waitcnt lgkmcnt(4)
  v_pk_add_f32 v[36:37], v[36:37], v[64:65]
  v_pk_add_f32 v[38:39], v[38:39], v[66:67]
  s_waitcnt lgkmcnt(3)
  v_pk_add_f32 v[20:21], v[20:21], v[48:49]
  v_pk_add_f32 v[22:23], v[22:23], v[50:51]
  s_waitcnt lgkmcnt(2)
  v_pk_add_f32 v[24:25], v[24:25], v[52:53]
  v_pk_add_f32 v[26:27], v[26:27], v[54:55]
  v_cvt_pk_bf16_f32 v192, v36, v37
  v_cvt_pk_bf16_f32 v194, v36, v37
  v_cvt_pk_bf16_f32 v193, v38, v39
  v_cvt_pk_bf16_f32 v195, v38, v39
  s_waitcnt lgkmcnt(1)
  v_pk_add_f32 v[28:29], v[28:29], v[56:57]
  v_pk_add_f32 v[30:31], v[30:31], v[58:59]
  s_waitcnt lgkmcnt(0)
  v_pk_add_f32 v[32:33], v[32:33], v[60:61]
  v_pk_add_f32 v[34:35], v[34:35], v[62:63]
  v_cvt_pk_bf16_f32 v184, v20, v24
  v_cvt_pk_bf16_f32 v185, v21, v25
  v_cvt_pk_bf16_f32 v186, v22, v26
  v_cvt_pk_bf16_f32 v187, v23, v27
  buffer_store_dwordx4 v[184:187], v5, s[12:15], s41 offen offset:0
  v_cvt_pk_bf16_f32 v188, v28, v32
  v_cvt_pk_bf16_f32 v189, v29, v33
  v_cvt_pk_bf16_f32 v190, v30, v34
  v_cvt_pk_bf16_f32 v191, v31, v35
  v_permlane16_swap_b32 v192, v194
  v_permlane16_swap_b32 v193, v195
  buffer_store_dwordx4 v[188:191], v5, s[12:15], s41 offen offset:64
  s_mov_b64 exec, s[54:55]
  buffer_store_dwordx4 v[192:195], v6, s[12:15], s42 offen offset:128
KM_END:
  s_endpgm
  s_endpgm
.section .rodata,"a"
.p2align 6
.amdhsa_kernel net_kernel
  .amdhsa_next_free_vgpr 512
  .amdhsa_next_free_sgpr 102
  .amdhsa_accum_offset 256
  .amdhsa_group_segment_fixed_size 0
  .amdhsa_kernarg_size 88
  .amdhsa_user_sgpr_count 2
  .amdhsa_user_sgpr_kernarg_segment_ptr 1
  .amdhsa_system_sgpr_workgroup_id_x 1
.end_amdhsa_kernel
```
